```python
import torch

def _softmax(x, axis=-1):
    return torch.softmax(x, dim=axis)
def _gelu(x):
    return torch.nn.functional.gelu(x, approximate="tanh")
def _silu(x):
    return torch.nn.functional.silu(x)
def _sigmoid(x):
    return torch.sigmoid(x)
def _layernorm(x, axis=-1, eps=1e-5):
    m = x.mean(dim=axis, keepdim=True)
    v = x.var(dim=axis, keepdim=True, unbiased=False)
    return (x - m) / torch.sqrt(v + eps)
def _scatter_add(tgt, idx, src, axis=0):
    return tgt.clone().index_add_(axis, idx, src)
def _segment_sum(src, seg, n):
    out = torch.zeros((n,) + src.shape[1:], dtype=src.dtype)
    return out.index_add_(0, seg, src)
def _pad(x, pw):
    flat = tuple(v for pair in reversed(pw) for v in pair)
    return torch.nn.functional.pad(x, flat)

kernel_name = 'standalone__cross_network_dcn_v2__recsys'

def setup_inputs():

    _w = (lambda a: (lambda t: t.to(torch.bfloat16) if t.is_floating_point() else t)(torch.as_tensor(a)))
    B, F, D, L = 16384, 100, 16, 3
    Din = min(F * D, 512)
    R = max(Din // 4, 2)
    sc = Din ** -0.5
    return {
        "x0": _w((lambda *s: torch.randn(*s, dtype=torch.bfloat16) * 0.05)(B, Din)),
        "U":  _w((lambda *s: torch.randn(*s, dtype=torch.bfloat16) * 1.6)(L, Din, R) * sc),
        "V":  _w((lambda *s: torch.randn(*s, dtype=torch.bfloat16) * 1.6)(L, R, Din) * sc),
        "bs": _w((lambda *s: torch.randn(*s, dtype=torch.bfloat16) * 0.05)(L, Din)),
    }

def reference(x0, U, V, bs):
    x = x0
    for l in range(U.shape[0]):
        h = torch.einsum('rd,bd->br', V[l], x)
        h = torch.einsum('dr,br->bd', U[l], h)
        x = x0 * (h + bs[l]) + x
    return x
```

```asm
; @launch grid=(256,1,1) block=(256,1,1) lds=163840
.amdgcn_target "amdgcn-amd-amdhsa--gfx950"
.text
.p2align 12
.globl standalone__cross_network_dcn_v2__recsys_kernel
.p2align 8
.type standalone__cross_network_dcn_v2__recsys_kernel,@function
standalone__cross_network_dcn_v2__recsys_kernel:
    s_cmp_ge_u32 s2, 0x100
    s_cbranch_scc1 L_done
    s_load_dwordx8 s[4:11], s[0:1], 0
    s_load_dwordx4 s[12:15], s[0:1], 32
    s_load_dwordx2 s[16:17], s[0:1], 48
    s_getpc_b64 s[18:19]
L_pc:
    s_lshr_b32 s3, s2, 3
    s_and_b32 s3, s3, 3
    s_lshl_b32 s3, s3, 13
    v_lshl_add_u32 v14, v0, 5, s3
    v_min_u32 v14, L_end-L_pc-4, v14
    v_add_co_u32 v14, vcc, s18, v14
    v_mov_b32 v15, s19
    v_addc_co_u32 v15, vcc, 0, v15, vcc
    global_load_dword v16, v[14:15], off
    v_lshrrev_b32 v2, 6, v0
    v_and_b32 v13, 63, v0
    v_readfirstlane_b32 s85, v2
    v_lshrrev_b32 v2, 4, v13
    v_xor_b32 v5, v2, v13
    v_and_b32 v4, 15, v5
    v_lshlrev_b32 v4, 4, v4
    s_lshl_b32 s72, s85, 8
    v_lshl_add_u32 v249, v2, 10, v4
    v_add_u32 v249, s72, v249
    s_mul_i32 s81, s85, 21760
    s_mul_i32 s80, s85, 17408
    s_add_u32 s80, s80, 87040
    s_lshl_b32 s83, s2, 16
    s_mul_i32 s82, s85, 32512
    s_mov_b32 s54, 0x10000
    s_mov_b32 s55, 0x20000
    s_mov_b32 s22, 274368
    s_mov_b32 s23, 0x20000
    s_mov_b64 s[26:27], s[22:23]
    s_mov_b64 s[30:31], s[22:23]
    s_mov_b64 s[34:35], s[22:23]
    v_lshrrev_b32 v6, 2, v13
    v_add_u32 v7, s85, v6
    v_and_b32 v7, 3, v7
    v_and_b32 v8, 3, v5
    v_lshl_add_u32 v7, v7, 2, v8
    v_lshlrev_b32 v7, 4, v7
    v_lshl_add_u32 v7, v2, 8, v7
    s_lshl_b32 s18, s85, 15
    v_add_u32 v250, s18, v7
    s_mov_b32 s38, 390336
    s_mov_b32 s39, 0x20000
    s_mov_b64 s[42:43], s[38:39]
    s_mov_b64 s[46:47], s[38:39]
    s_mov_b64 s[50:51], s[38:39]
    v_and_b32 v6, 3, v6
    v_and_b32 v9, 3, v13
    v_mul_u32_u24 v10, 0x440, v6
    v_lshl_add_u32 v10, v9, 8, v10
    v_lshl_add_u32 v10, v8, 4, v10
    v_add_u32 v244, s80, v10
    v_lshlrev_b32 v96, 4, v13
    v_add_u32 v252, s81, v10
    v_add_u32 v245, s81, v96
    s_add_u32 s3, s85, 1
    s_and_b32 s3, s3, 3
    s_lshl_b32 s73, s3, 8
    s_mul_i32 s3, s3, 21760
    v_add_u32 v253, s3, v10
    v_add_u32 v246, s3, v96
    s_add_u32 s3, s85, 2
    s_and_b32 s3, s3, 3
    s_lshl_b32 s74, s3, 8
    s_mul_i32 s3, s3, 21760
    v_add_u32 v254, s3, v10
    v_add_u32 v247, s3, v96
    s_add_u32 s3, s85, 3
    s_and_b32 s3, s3, 3
    s_lshl_b32 s75, s3, 8
    s_mul_i32 s3, s3, 21760
    v_add_u32 v255, s3, v10
    v_add_u32 v248, s3, v96
    s_lshr_b32 s3, s2, 3
    s_lshl_b32 s3, s3, 1
    s_bfe_u32 s19, s2, 0x10001
    s_add_u32 s19, s3, s19
    s_and_b32 s3, s2, 5
    s_cselect_b32 s19, 0xffff, s19
    s_waitcnt lgkmcnt(0)
    s_add_u32 s52, s4, s83
    s_addc_u32 s53, s5, 0
    s_mov_b32 m0, s81
    s_nop 0
    buffer_load_dwordx4 v249, s[52:55], 0 offen nt lds
    s_add_u32 m0, s81, 1088
    s_mov_b32 s76, 4096
    s_nop 0
    buffer_load_dwordx4 v249, s[52:55], s76 offen nt lds
    s_mov_b64 s[56:57], s[14:15]
    s_mov_b32 s0, s19
    s_mov_b64 s[36:37], s[6:7]
    s_add_u32 s40, s6, 960
    s_addc_u32 s41, s7, 0
    s_add_u32 s44, s6, 1920
    s_addc_u32 s45, s7, 0
    s_add_u32 s48, s6, 2880
    s_addc_u32 s49, s7, 0
    s_add_u32 s20, s8, s82
    s_addc_u32 s21, s9, 0
    s_add_u32 s24, s20, 7104
    s_addc_u32 s25, s21, 0
    s_add_u32 s28, s20, 14208
    s_addc_u32 s29, s21, 0
    s_add_u32 s32, s20, 21312
    s_addc_u32 s33, s21, 0
    s_cmp_lt_u32 s0, 40
    s_cbranch_scc0 L_Pe
    s_add_u32 m0, s81, 17408
    s_lshr_b32 s3, s0, 3
    s_lshl_b32 s82, s3, 17
    s_add_u32 s3, s3, 1
    s_and_b32 s14, s0, 7
    s_lshl_b32 s14, s14, 12
    s_add_u32 s82, s82, s14
    s_lshl_b32 s14, s85, 15
    s_add_u32 s82, s82, s14
    s_lshr_b32 s15, s3, 1
    s_lshl_b32 s15, s15, 17
    s_bfe_u32 s14, s0, 0x20001
    s_bitcmp1_b32 s3, 0
    s_cbranch_scc1 L_Pu
    s_add_u32 s14, s14, s85
    s_and_b32 s14, s14, 3
    s_lshl_b32 s14, s14, 8
    s_add_u32 s15, s15, s14
    s_and_b32 s14, s0, 1
    s_lshl_b32 s14, s14, 12
    s_add_u32 s15, s15, s14
    buffer_load_dwordx4 v249, s[20:23], s15 offen offset:0 lds
    buffer_load_dwordx4 v249, s[24:27], s15 offen offset:1088 lds
    buffer_load_dwordx4 v249, s[28:31], s15 offen offset:2176 lds
    buffer_load_dwordx4 v249, s[32:35], s15 offen offset:3264 lds
    s_branch L_Pe
L_Pu:
    s_lshl_b32 s14, s14, 13
    s_add_u32 s15, s15, s14
    s_and_b32 s14, s0, 1
    s_lshl_b32 s14, s14, 10
    s_add_u32 s15, s15, s14
    buffer_load_dwordx4 v250, s[36:39], s15 offen offset:0 lds
    buffer_load_dwordx4 v250, s[40:43], s15 offen offset:1088 lds
    buffer_load_dwordx4 v250, s[44:47], s15 offen offset:2176 lds
    buffer_load_dwordx4 v250, s[48:51], s15 offen offset:3264 lds
L_Pe:
    s_add_u32 m0, s80, 0
    s_add_u32 s77, s72, 0
    s_nop 0
    buffer_load_dwordx4 v249, s[20:23], s77 offen offset:0 lds
    s_add_u32 m0, s81, 2176
    s_mov_b32 s78, 8192
    s_nop 0
    buffer_load_dwordx4 v249, s[52:55], s78 offen nt lds
    s_add_u32 m0, s80, 0
    s_add_u32 s79, s72, 0
    s_mul_i32 s3, s85, 1536
    s_add_u32 s3, s3, 156672
    v_lshlrev_b32 v5, 5, v2
    v_add_u32 v251, s3, v5
    v_min_u32 v5, 2, v2
    v_and_b32 v7, 15, v13
    v_lshlrev_b32 v8, 5, v7
    v_lshl_add_u32 v8, v5, 9, v8
    v_add_u32 v98, s3, v8
    v_lshlrev_b32 v8, 4, v7
    v_lshl_add_u32 v8, v5, 10, v8
    v_add_u32 v97, s72, v8
    s_lshr_b32 s3, s2, 3
    s_lshl_b32 s3, s3, 10
    s_add_u32 s19, s72, s3
    v_add_u32 v123, s19, v96
    s_add_u32 s3, s3, s18
    v_lshrrev_b32 v7, 7, v96
    v_and_b32 v8, 127, v96
    v_lshl_add_u32 v125, v7, 9, v8
    s_mov_b32 s64, 0
    s_mov_b32 s65, 4096
    s_mov_b32 s66, 8192
    s_mov_b32 s67, 12288
    s_mov_b32 s68, 16384
    s_mov_b32 s69, 20480
    s_mov_b32 s70, 24576
    s_mov_b32 s71, 28672
    s_mov_b32 s84, 0xffff0000
    v_mov_b32 v124, 1
    v_min_u32 v127, 39, v13
    v_and_b32 v7, 1, v127
    v_lshlrev_b32 v127, 1, v127
    v_and_b32 v127, 0x7c, v127
    v_lshl_add_u32 v127, v7, 7, v127
    s_mov_b32 s62, 3072
    s_mov_b32 s63, 0x20000
    s_mov_b32 s58, 0x100
    s_mov_b32 s59, 0x20000
    s_lshr_b32 s3, s0, 1
    s_lshl_b32 s3, s3, 2
    s_and_b32 s19, s0, 1
    s_lshl_b32 s19, s19, 7
    s_add_u32 s3, s3, s19
    v_lshl_add_u32 v99, v13, 8, s3
    s_mov_b64 s[60:61], s[10:11]
    s_mov_b32 s18, 655360
    s_mov_b32 s19, 0x20000
    s_add_u32 s36, s16, 4096
    s_addc_u32 s37, s17, 0
    s_add_u32 s38, s16, 12288
    s_addc_u32 s39, s17, 0
    s_add_u32 s40, s16, 20480
    s_addc_u32 s41, s17, 0
    s_add_u32 s42, s16, 28672
    s_addc_u32 s43, s17, 0
    buffer_load_dwordx4 a[232:235], v123, s[20:23], 0 offen
    buffer_load_dwordx4 v249, s[24:27], s79 offen offset:1088 lds
    s_add_u32 m0, s81, 3264
    s_mov_b32 s76, 12288
    s_nop 0
    buffer_load_dwordx4 v249, s[52:55], s76 offen nt lds
    s_add_u32 m0, s80, 0
    s_add_u32 s77, s72, 0
    s_nop 0
    buffer_load_dwordx4 v249, s[28:31], s77 offen offset:2176 lds
    s_add_u32 m0, s81, 4352
    s_mov_b32 s78, 16384
    s_nop 0
    buffer_load_dwordx4 v249, s[52:55], s78 offen nt lds
    s_add_u32 m0, s80, 0
    s_add_u32 s79, s72, 0
    s_cmp_lt_u32 s0, 40
    s_cbranch_scc0 L_Se
    s_waitcnt vmcnt(7)
    ds_read_b128 a[240:243], v252 offset:17408
    ds_read_b128 a[244:247], v252 offset:17472
    ds_read_b128 a[248:251], v252 offset:17536
    ds_read_b128 a[252:255], v252 offset:17600
    s_waitcnt lgkmcnt(0)
    buffer_store_dwordx4 a[240:243], v125, s[16:19], s82 offen offset:0 sc1
    buffer_store_dwordx4 a[244:247], v125, s[16:19], s82 offen offset:128 sc1
    buffer_store_dwordx4 a[248:251], v125, s[16:19], s82 offen offset:256 sc1
    buffer_store_dwordx4 a[252:255], v125, s[16:19], s82 offen offset:384 sc1
    s_nop 1
L_Se:
    buffer_load_dwordx4 v249, s[32:35], s79 offen offset:3264 lds
    s_add_u32 m0, s81, 5440
    s_mov_b32 s76, 20480
    s_nop 0
    buffer_load_dwordx4 v249, s[52:55], s76 offen nt lds
    s_add_u32 m0, s80, 4352
    s_add_u32 s77, s72, 4096
    s_nop 0
    buffer_load_dwordx4 v249, s[20:23], s77 offen offset:0 lds
    s_add_u32 m0, s81, 6528
    s_mov_b32 s78, 24576
    s_nop 0
    buffer_load_dwordx4 v249, s[52:55], s78 offen nt lds
    s_add_u32 m0, s80, 4352
    s_add_u32 s79, s72, 4096
    s_nop 0
    buffer_load_dwordx4 v249, s[24:27], s79 offen offset:1088 lds
    s_add_u32 m0, s81, 7616
    s_mov_b32 s76, 28672
    s_nop 0
    buffer_load_dwordx4 v249, s[52:55], s76 offen nt lds
    s_add_u32 m0, s80, 4352
    s_add_u32 s77, s72, 4096
    s_nop 0
    buffer_load_dwordx4 v249, s[28:31], s77 offen offset:2176 lds
    s_add_u32 m0, s81, 8704
    s_mov_b32 s78, 32768
    buffer_load_dwordx4 v[100:103], v97, s[60:63], 0 offen
    buffer_load_dwordx4 v249, s[52:55], s78 offen nt lds
    s_add_u32 m0, s80, 4352
    s_add_u32 s79, s72, 4096
    s_nop 0
    buffer_load_dwordx4 v249, s[32:35], s79 offen offset:3264 lds
    s_add_u32 m0, s81, 9792
    s_mov_b32 s76, 36864
    s_waitcnt vmcnt(12)
    ds_read_b128 v[128:131], v252 offset:0
    ds_read_b128 v[132:135], v252 offset:64
    ds_read_b128 v[136:139], v252 offset:128
    ds_read_b128 v[140:143], v252 offset:192
    buffer_load_dwordx4 v249, s[52:55], s76 offen nt lds
    s_add_u32 m0, s80, 8704
    s_add_u32 s77, s73, 0
    s_cmp_lt_u32 s0, 40
    s_cbranch_scc0 L_Fe
    s_waitcnt vmcnt(11)
    s_barrier
    s_cmp_eq_u32 s85, 0
    s_cbranch_scc0 L_Fe
    buffer_store_dword v124, v99, s[56:59], 0 offen sc1
L_Fe:
    s_waitcnt lgkmcnt(3)
    v_lshlrev_b32 v0, 16, v128
    v_and_b32 v1, s84, v128
    v_lshlrev_b32 v2, 16, v129
    v_and_b32 v3, s84, v129
    v_lshlrev_b32 v4, 16, v130
    v_and_b32 v5, s84, v130
    v_lshlrev_b32 v6, 16, v131
    v_and_b32 v7, s84, v131
    s_waitcnt lgkmcnt(0)
    v_lshlrev_b32 v8, 16, v132
    v_and_b32 v9, s84, v132
    v_lshlrev_b32 v10, 16, v133
    v_and_b32 v11, s84, v133
    v_lshlrev_b32 v12, 16, v134
    v_and_b32 v13, s84, v134
    v_lshlrev_b32 v14, 16, v135
    v_and_b32 v15, s84, v135
    v_lshlrev_b32 v16, 16, v136
    v_and_b32 v17, s84, v136
    v_lshlrev_b32 v18, 16, v137
    v_and_b32 v19, s84, v137
    v_lshlrev_b32 v20, 16, v138
    v_and_b32 v21, s84, v138
    v_lshlrev_b32 v22, 16, v139
    v_and_b32 v23, s84, v139
    v_lshlrev_b32 v24, 16, v140
    v_and_b32 v25, s84, v140
    v_lshlrev_b32 v26, 16, v141
    v_and_b32 v27, s84, v141
    v_lshlrev_b32 v28, 16, v142
    v_and_b32 v29, s84, v142
    v_lshlrev_b32 v30, 16, v143
    v_and_b32 v31, s84, v143
    buffer_load_dwordx4 v249, s[20:23], s77 offen offset:0 lds
    s_add_u32 m0, s81, 10880
    s_mov_b32 s78, 40960
    s_nop 0
    buffer_load_dwordx4 v249, s[52:55], s78 offen nt lds
    s_add_u32 m0, s80, 8704
    s_add_u32 s79, s73, 0
    s_waitcnt vmcnt(12)
    ds_read_b128 a[0:3], v244 offset:0
    ds_read_b128 a[4:7], v244 offset:64
    ds_read_b128 a[8:11], v244 offset:128
    ds_read_b128 a[12:15], v244 offset:192
    s_waitcnt lgkmcnt(0)
    v_mfma_f32_16x16x32_bf16 v[192:195], a[0:3], v[128:131], 0
    v_mfma_f32_16x16x32_bf16 v[192:195], a[4:7], v[132:135], v[192:195]
    v_mfma_f32_16x16x32_bf16 v[192:195], a[8:11], v[136:139], v[192:195]
    v_mfma_f32_16x16x32_bf16 v[192:195], a[12:15], v[140:143], v[192:195]
    buffer_load_dwordx4 v249, s[24:27], s79 offen offset:1088 lds
    s_add_u32 m0, s81, 11968
    s_mov_b32 s76, 45056
    s_nop 0
    buffer_load_dwordx4 v249, s[52:55], s76 offen nt lds
    s_add_u32 m0, s80, 8704
    s_add_u32 s77, s73, 0
    s_nop 0
    buffer_load_dwordx4 v249, s[28:31], s77 offen offset:2176 lds
    s_add_u32 m0, s81, 13056
    s_mov_b32 s78, 49152
    s_nop 0
    buffer_load_dwordx4 v249, s[52:55], s78 offen nt lds
    s_add_u32 m0, s80, 8704
    s_add_u32 s79, s73, 0
    s_nop 0
    buffer_load_dwordx4 v249, s[32:35], s79 offen offset:3264 lds
    s_add_u32 m0, s81, 14144
    s_mov_b32 s76, 53248
    s_waitcnt vmcnt(12)
    ds_read_b128 v[144:147], v252 offset:4352
    ds_read_b128 v[148:151], v252 offset:4416
    ds_read_b128 v[152:155], v252 offset:4480
    ds_read_b128 v[156:159], v252 offset:4544
    s_barrier
    ds_read_b128 a[192:195], v253 offset:0
    ds_read_b128 a[196:199], v253 offset:64
    ds_read_b128 a[200:203], v253 offset:128
    ds_read_b128 a[204:207], v253 offset:192
    ds_read_b128 a[208:211], v253 offset:4352
    ds_read_b128 a[212:215], v253 offset:4416
    ds_read_b128 a[216:219], v253 offset:4480
    buffer_load_dwordx4 v249, s[52:55], s76 offen nt lds
    s_add_u32 m0, s80, 13056
    s_add_u32 s77, s73, 4096
    s_mov_b64 exec, 0
    s_cmp_eq_u32 s85, 0
    s_cbranch_scc1 L_st0
    s_cmp_eq_u32 s85, 1
    s_cbranch_scc1 L_st1
    s_cmp_eq_u32 s85, 2
    s_cbranch_scc1 L_st2
    s_branch L_st3
L_wret:
    s_mov_b64 exec, -1
    ds_read_b128 a[220:223], v253 offset:4544
    ds_read_b128 a[240:243], v254 offset:0
    ds_read_b128 a[244:247], v254 offset:64
    ds_read_b128 a[248:251], v254 offset:128
    ds_read_b128 a[252:255], v254 offset:192
    buffer_load_dwordx4 v249, s[20:23], s77 offen offset:0 lds
    s_add_u32 m0, s81, 15232
    s_mov_b32 s78, 57344
    s_waitcnt vmcnt(12) lgkmcnt(12)
    v_lshlrev_b32 v104, 16, v100
    v_and_b32 v105, s84, v100
    v_lshlrev_b32 v106, 16, v101
    v_and_b32 v107, s84, v101
    ds_write_b128 v98, v[104:107] offset:0
    v_lshlrev_b32 v108, 16, v102
    v_and_b32 v109, s84, v102
    v_mfma_f32_16x16x32_bf16 v[196:199], a[0:3], v[144:147], 0
    v_lshlrev_b32 v110, 16, v103
    v_and_b32 v111, s84, v103
    v_mfma_f32_16x16x32_bf16 v[196:199], a[4:7], v[148:151], v[196:199]
    ds_write_b128 v98, v[108:111] offset:16
    v_mfma_f32_16x16x32_bf16 v[196:199], a[8:11], v[152:155], v[196:199]
    v_lshlrev_b32 v32, 16, v144
    v_and_b32 v33, s84, v144
    v_mfma_f32_16x16x32_bf16 v[196:199], a[12:15], v[156:159], v[196:199]
    v_lshlrev_b32 v34, 16, v145
    v_and_b32 v35, s84, v145
    ds_read_b128 v[232:235], v251 offset:0
    ds_read_b128 v[236:239], v251 offset:16
    ds_read_b128 v[240:243], v251 offset:128
    v_lshlrev_b32 v36, 16, v146
    v_and_b32 v37, s84, v146
    v_lshlrev_b32 v38, 16, v147
    v_and_b32 v39, s84, v147
    v_lshlrev_b32 v40, 16, v148
    v_and_b32 v41, s84, v148
    v_lshlrev_b32 v42, 16, v149
    v_and_b32 v43, s84, v149
    v_lshlrev_b32 v44, 16, v150
    v_and_b32 v45, s84, v150
    v_lshlrev_b32 v46, 16, v151
    v_and_b32 v47, s84, v151
    v_lshlrev_b32 v48, 16, v152
    buffer_load_dwordx4 v249, s[52:55], s78 offen nt lds
    s_add_u32 m0, s80, 13056
    s_add_u32 s79, s73, 4096
    v_and_b32 v49, s84, v152
    v_lshlrev_b32 v50, 16, v153
    v_and_b32 v51, s84, v153
    v_lshlrev_b32 v52, 16, v154
    v_and_b32 v53, s84, v154
    v_lshlrev_b32 v54, 16, v155
    v_and_b32 v55, s84, v155
    v_lshlrev_b32 v56, 16, v156
    v_and_b32 v57, s84, v156
    v_lshlrev_b32 v58, 16, v157
    v_and_b32 v59, s84, v157
    v_lshlrev_b32 v60, 16, v158
    buffer_load_dwordx4 v249, s[24:27], s79 offen offset:1088 lds
    s_add_u32 m0, s81, 16320
    s_mov_b32 s76, 61440
    s_waitcnt vmcnt(12) lgkmcnt(0)
    ds_read_b128 a[16:19], v244 offset:4352
    ds_read_b128 a[20:23], v244 offset:4416
    ds_read_b128 a[24:27], v244 offset:4480
    ds_read_b128 a[28:31], v244 offset:4544
    v_and_b32 v61, s84, v158
    v_lshlrev_b32 v62, 16, v159
    v_and_b32 v63, s84, v159
    s_waitcnt lgkmcnt(0)
    v_mfma_f32_16x16x32_bf16 v[200:203], a[16:19], v[128:131], 0
    v_mfma_f32_16x16x32_bf16 v[200:203], a[20:23], v[132:135], v[200:203]
    v_mfma_f32_16x16x32_bf16 v[200:203], a[24:27], v[136:139], v[200:203]
    v_mfma_f32_16x16x32_bf16 v[200:203], a[28:31], v[140:143], v[200:203]
    v_mfma_f32_16x16x32_bf16 v[204:207], a[16:19], v[144:147], 0
    buffer_load_dwordx4 v249, s[52:55], s76 offen nt lds
    v_mfma_f32_16x16x32_bf16 v[204:207], a[20:23], v[148:151], v[204:207]
    s_add_u32 m0, s80, 13056
    s_add_u32 s77, s73, 4096
    v_mfma_f32_16x16x32_bf16 v[204:207], a[24:27], v[152:155], v[204:207]
    v_mfma_f32_16x16x32_bf16 v[204:207], a[28:31], v[156:159], v[204:207]
    buffer_load_dwordx4 v249, s[28:31], s77 offen offset:2176 lds
    s_add_u32 m0, s80, 13056
    s_add_u32 s78, s73, 4096
    s_nop 0
    buffer_load_dwordx4 v249, s[32:35], s78 offen offset:3264 lds
    s_add_u32 m0, s80, 0
    s_add_u32 s79, s74, 0
    s_nop 0
    buffer_load_dwordx4 v249, s[20:23], s79 offen offset:0 lds
    buffer_load_dwordx4 v249, s[24:27], s79 offen offset:1088 lds
    s_waitcnt vmcnt(12)
    ds_read_b128 v[160:163], v252 offset:8704
    ds_read_b128 v[164:167], v252 offset:8768
    ds_read_b128 v[168:171], v252 offset:8832
    ds_read_b128 v[172:175], v252 offset:8896
    buffer_load_dwordx4 v249, s[28:31], s79 offen offset:2176 lds
    s_waitcnt lgkmcnt(3)
    v_lshlrev_b32 v64, 16, v160
    v_and_b32 v65, s84, v160
    v_lshlrev_b32 v66, 16, v161
    v_and_b32 v67, s84, v161
    v_lshlrev_b32 v68, 16, v162
    v_and_b32 v69, s84, v162
    v_lshlrev_b32 v70, 16, v163
    v_and_b32 v71, s84, v163
    s_waitcnt lgkmcnt(0)
    v_lshlrev_b32 v72, 16, v164
    v_and_b32 v73, s84, v164
    v_lshlrev_b32 v74, 16, v165
    v_and_b32 v75, s84, v165
    v_mfma_f32_16x16x32_bf16 v[208:211], a[0:3], v[160:163], 0
    v_lshlrev_b32 v76, 16, v166
    v_and_b32 v77, s84, v166
    v_mfma_f32_16x16x32_bf16 v[208:211], a[4:7], v[164:167], v[208:211]
    v_lshlrev_b32 v78, 16, v167
    v_and_b32 v79, s84, v167
    v_mfma_f32_16x16x32_bf16 v[208:211], a[8:11], v[168:171], v[208:211]
    v_lshlrev_b32 v80, 16, v168
    v_and_b32 v81, s84, v168
    v_mfma_f32_16x16x32_bf16 v[208:211], a[12:15], v[172:175], v[208:211]
    v_lshlrev_b32 v82, 16, v169
    v_and_b32 v83, s84, v169
    v_mfma_f32_16x16x32_bf16 v[212:215], a[16:19], v[160:163], 0
    v_lshlrev_b32 v84, 16, v170
    v_and_b32 v85, s84, v170
    v_mfma_f32_16x16x32_bf16 v[212:215], a[20:23], v[164:167], v[212:215]
    v_lshlrev_b32 v86, 16, v171
    v_and_b32 v87, s84, v171
    v_mfma_f32_16x16x32_bf16 v[212:215], a[24:27], v[168:171], v[212:215]
    v_lshlrev_b32 v88, 16, v172
    v_and_b32 v89, s84, v172
    v_mfma_f32_16x16x32_bf16 v[212:215], a[28:31], v[172:175], v[212:215]
    v_lshlrev_b32 v90, 16, v173
    v_and_b32 v91, s84, v173
    buffer_load_dwordx4 v249, s[32:35], s79 offen offset:3264 lds
    s_add_u32 m0, s80, 4352
    s_add_u32 s76, s74, 4096
    v_lshlrev_b32 v92, 16, v174
    v_and_b32 v93, s84, v174
    v_lshlrev_b32 v94, 16, v175
    v_and_b32 v95, s84, v175
    buffer_load_dwordx4 v249, s[20:23], s76 offen offset:0 lds
    s_waitcnt vmcnt(12)
    ds_read_b128 a[32:35], v244 offset:8704
    ds_read_b128 a[36:39], v244 offset:8768
    ds_read_b128 a[40:43], v244 offset:8832
    ds_read_b128 a[44:47], v244 offset:8896
    s_waitcnt lgkmcnt(0)
    v_mfma_f32_16x16x32_bf16 v[192:195], a[32:35], a[192:195], v[192:195]
    v_mfma_f32_16x16x32_bf16 v[192:195], a[36:39], a[196:199], v[192:195]
    v_mfma_f32_16x16x32_bf16 v[192:195], a[40:43], a[200:203], v[192:195]
    v_mfma_f32_16x16x32_bf16 v[192:195], a[44:47], a[204:207], v[192:195]
    v_mfma_f32_16x16x32_bf16 v[196:199], a[32:35], a[208:211], v[196:199]
    buffer_load_dwordx4 v249, s[24:27], s76 offen offset:1088 lds
    v_mfma_f32_16x16x32_bf16 v[196:199], a[36:39], a[212:215], v[196:199]
    v_mfma_f32_16x16x32_bf16 v[196:199], a[40:43], a[216:219], v[196:199]
    v_mfma_f32_16x16x32_bf16 v[196:199], a[44:47], a[220:223], v[196:199]
    buffer_load_dwordx4 v249, s[28:31], s76 offen offset:2176 lds
    buffer_load_dwordx4 v249, s[32:35], s76 offen offset:3264 lds
    s_add_u32 m0, s80, 8704
    s_add_u32 s77, s75, 0
    buffer_load_dword v126, v127, s[56:59], 0 offen sc1
    buffer_load_dwordx4 v249, s[20:23], s77 offen offset:0 lds
    s_waitcnt vmcnt(12)
    ds_read_b128 v[176:179], v252 offset:13056
    ds_read_b128 v[180:183], v252 offset:13120
    ds_read_b128 v[184:187], v252 offset:13184
    ds_read_b128 v[188:191], v252 offset:13248
    s_barrier
    ds_read_b128 a[224:227], v253 offset:8704
    ds_read_b128 a[228:231], v253 offset:8768
    ds_read_b128 a[232:235], v253 offset:8832
    ds_read_b128 a[236:239], v253 offset:8896
    buffer_load_dwordx4 v249, s[24:27], s77 offen offset:1088 lds
    s_waitcnt lgkmcnt(7)
    buffer_load_dwordx4 v249, s[28:31], s77 offen offset:2176 lds
    v_and_b32 v97, s84, v176
    v_lshlrev_b32 v98, 16, v177
    s_waitcnt vmcnt(12) lgkmcnt(4)
    ds_read_b128 a[48:51], v244 offset:13056
    ds_read_b128 a[52:55], v244 offset:13120
    ds_read_b128 a[56:59], v244 offset:13184
    ds_read_b128 a[60:63], v244 offset:13248
    v_and_b32 v99, s84, v177
    v_lshlrev_b32 v100, 16, v178
    v_and_b32 v101, s84, v178
    v_lshlrev_b32 v102, 16, v179
    v_mfma_f32_16x16x32_bf16 v[216:219], a[0:3], v[176:179], 0
L_st0:
    s_cbranch_execz L_wret
    v_and_b32 v103, s84, v179
    v_lshlrev_b32 v104, 16, v180
    v_mfma_f32_16x16x32_bf16 v[216:219], a[4:7], v[180:183], v[216:219]
    buffer_load_dwordx4 v249, s[32:35], s77 offen offset:3264 lds
    v_mfma_f32_16x16x32_bf16 v[216:219], a[8:11], v[184:187], v[216:219]
    s_add_u32 m0, s80, 13056
    s_add_u32 s78, s75, 4096
    v_and_b32 v105, s84, v180
    v_mfma_f32_16x16x32_bf16 v[216:219], a[12:15], v[188:191], v[216:219]
    v_lshlrev_b32 v106, 16, v181
    v_and_b32 v107, s84, v181
    v_mfma_f32_16x16x32_bf16 v[220:223], a[16:19], v[176:179], 0
    v_lshlrev_b32 v108, 16, v182
    v_and_b32 v109, s84, v182
    v_mfma_f32_16x16x32_bf16 v[220:223], a[20:23], v[180:183], v[220:223]
    v_lshlrev_b32 v110, 16, v183
    v_and_b32 v111, s84, v183
    v_mfma_f32_16x16x32_bf16 v[220:223], a[24:27], v[184:187], v[220:223]
    s_waitcnt lgkmcnt(0)
    buffer_load_dwordx4 v249, s[20:23], s78 offen offset:0 lds
    v_mfma_f32_16x16x32_bf16 v[220:223], a[28:31], v[188:191], v[220:223]
    v_lshlrev_b32 v124, 16, v190
    v_mfma_f32_16x16x32_bf16 v[200:203], a[48:51], a[192:195], v[200:203]
    ds_read_b128 a[192:195], v254 offset:4352
    v_mfma_f32_16x16x32_bf16 v[200:203], a[52:55], a[196:199], v[200:203]
    ds_read_b128 a[196:199], v254 offset:4416
    v_mfma_f32_16x16x32_bf16 v[200:203], a[56:59], a[200:203], v[200:203]
    ds_read_b128 a[200:203], v254 offset:4480
    v_mfma_f32_16x16x32_bf16 v[200:203], a[60:63], a[204:207], v[200:203]
    buffer_load_dwordx4 v249, s[24:27], s78 offen offset:1088 lds
    v_mfma_f32_16x16x32_bf16 v[204:207], a[48:51], a[208:211], v[204:207]
    ds_read_b128 a[204:207], v254 offset:4544
    ds_read_b128 a[208:211], v253 offset:13056
    v_mfma_f32_16x16x32_bf16 v[204:207], a[52:55], a[212:215], v[204:207]
    buffer_load_dwordx4 v249, s[28:31], s78 offen offset:2176 lds
    v_mfma_f32_16x16x32_bf16 v[204:207], a[56:59], a[216:219], v[204:207]
    s_waitcnt vmcnt(12)
    ds_read_b128 a[64:67], v244 offset:0
    ds_read_b128 a[68:71], v244 offset:64
    v_mfma_f32_16x16x32_bf16 v[204:207], a[60:63], a[220:223], v[204:207]
    ds_read_b128 a[72:75], v244 offset:128
    ds_read_b128 a[76:79], v244 offset:192
    v_mfma_f32_16x16x32_bf16 v[208:211], a[32:35], a[224:227], v[208:211]
    ds_read_b128 a[212:215], v253 offset:13120
    ds_read_b128 a[216:219], v253 offset:13184
    v_mfma_f32_16x16x32_bf16 v[208:211], a[36:39], a[228:231], v[208:211]
    buffer_load_dwordx4 v249, s[32:35], s78 offen offset:3264 lds
    v_mfma_f32_16x16x32_bf16 v[208:211], a[40:43], a[232:235], v[208:211]
    ds_read_b128 a[220:223], v253 offset:13248
    v_subrev_u32 v249, s81, v245
    v_mfma_f32_16x16x32_bf16 v[208:211], a[44:47], a[236:239], v[208:211]
    v_and_b32 v249, 0xf0, v249
    v_lshlrev_b32 v249, 3, v249
    v_mfma_f32_16x16x32_bf16 v[212:215], a[48:51], a[224:227], v[212:215]
    ds_read_b128 a[224:227], v255 offset:0
    v_mfma_f32_16x16x32_bf16 v[212:215], a[52:55], a[228:231], v[212:215]
    ds_read_b128 a[228:231], v255 offset:64
    v_mfma_f32_16x16x32_bf16 v[212:215], a[56:59], a[232:235], v[212:215]
    ds_read_b128 a[232:235], v255 offset:128
    v_mfma_f32_16x16x32_bf16 v[212:215], a[60:63], a[236:239], v[212:215]
    s_waitcnt lgkmcnt(6)
    ds_read_b128 a[236:239], v255 offset:192
    v_mfma_f32_16x16x32_bf16 v[192:195], a[64:67], a[240:243], v[192:195]
    v_mfma_f32_16x16x32_bf16 v[192:195], a[68:71], a[244:247], v[192:195]
    v_mfma_f32_16x16x32_bf16 v[192:195], a[72:75], a[248:251], v[192:195]
    v_mfma_f32_16x16x32_bf16 v[192:195], a[76:79], a[252:255], v[192:195]
    v_mfma_f32_16x16x32_bf16 v[196:199], a[64:67], a[192:195], v[196:199]
    v_mfma_f32_16x16x32_bf16 v[196:199], a[68:71], a[196:199], v[196:199]
    v_mfma_f32_16x16x32_bf16 v[196:199], a[72:75], a[200:203], v[196:199]
    v_mfma_f32_16x16x32_bf16 v[196:199], a[76:79], a[204:207], v[196:199]
    s_waitcnt vmcnt(9) lgkmcnt(0)
    ds_read_b128 a[80:83], v244 offset:4352
    ds_read_b128 a[84:87], v244 offset:4416
    ds_read_b128 a[88:91], v244 offset:4480
    ds_read_b128 a[92:95], v244 offset:4544
    s_waitcnt vmcnt(8)
    v_cmp_eq_u32 vcc, 0, v126
    s_cbranch_vccnz L_spin
L_back:
    s_lshl_b32 s3, s85, 15
    v_add_u32 v250, s3, v125
    v_lshlrev_b32 v96, 16, v176
    v_lshlrev_b32 v112, 16, v184
    v_and_b32 v113, s84, v184
    global_load_dwordx4 a[128:131], v250, s[36:37] offset:-4096 sc1
    v_lshlrev_b32 v114, 16, v185
    v_and_b32 v115, s84, v185
    v_lshlrev_b32 v116, 16, v186
    v_and_b32 v117, s84, v186
    v_lshlrev_b32 v118, 16, v187
    v_and_b32 v119, s84, v187
    v_lshlrev_b32 v120, 16, v188
    v_and_b32 v121, s84, v188
    v_lshlrev_b32 v122, 16, v189
    v_and_b32 v123, s84, v189
    v_and_b32 v125, s84, v190
    s_waitcnt lgkmcnt(0)
    s_sub_u32 s3, s80, s81
    v_lshlrev_b32 v126, 16, v191
    v_and_b32 v127, s84, v191
    v_mfma_f32_16x16x32_bf16 v[200:203], a[80:83], a[240:243], v[200:203]
    global_load_dwordx4 a[132:135], v250, s[36:37] offset:-3968 sc1
    ds_read_b128 a[240:243], v255 offset:4352
    v_mfma_f32_16x16x32_bf16 v[200:203], a[84:87], a[244:247], v[200:203]
    ds_read_b128 a[244:247], v255 offset:4416
    v_mfma_f32_16x16x32_bf16 v[200:203], a[88:91], a[248:251], v[200:203]
    ds_read_b128 a[248:251], v255 offset:4480
    v_mfma_f32_16x16x32_bf16 v[200:203], a[92:95], a[252:255], v[200:203]
    ds_read_b128 a[252:255], v255 offset:4544
    v_mfma_f32_16x16x32_bf16 v[204:207], a[80:83], a[192:195], v[204:207]
    global_load_dwordx4 a[136:139], v250, s[36:37] offset:-3840 sc1
    ds_read_b128 a[192:195], v254 offset:8704
    v_mfma_f32_16x16x32_bf16 v[204:207], a[84:87], a[196:199], v[204:207]
    ds_read_b128 a[196:199], v254 offset:8768
    v_mfma_f32_16x16x32_bf16 v[204:207], a[88:91], a[200:203], v[204:207]
    ds_read_b128 a[200:203], v254 offset:8832
    v_mfma_f32_16x16x32_bf16 v[204:207], a[92:95], a[204:207], v[204:207]
    ds_read_b128 a[204:207], v254 offset:8896
    v_mfma_f32_16x16x32_bf16 v[216:219], a[32:35], a[208:211], v[216:219]
    global_load_dwordx4 a[140:143], v250, s[36:37] offset:-3712 sc1
    v_mfma_f32_16x16x32_bf16 v[216:219], a[36:39], a[212:215], v[216:219]
    s_add_u32 s56, s12, s83
    s_addc_u32 s57, s13, 0
    s_mov_b32 s58, 65536
    s_mov_b32 s59, 0x20000
    v_mfma_f32_16x16x32_bf16 v[216:219], a[40:43], a[216:219], v[216:219]
    s_waitcnt vmcnt(8) lgkmcnt(5)
    ds_read_b128 a[96:99], v244 offset:8704
    ds_read_b128 a[100:103], v244 offset:8768
    v_mfma_f32_16x16x32_bf16 v[216:219], a[44:47], a[220:223], v[216:219]
    ds_read_b128 a[104:107], v244 offset:8832
    ds_read_b128 a[108:111], v244 offset:8896
    v_mfma_f32_16x16x32_bf16 v[220:223], a[48:51], a[208:211], v[220:223]
    global_load_dwordx4 a[144:147], v250, s[36:37] offset:0 sc1
    ds_read_b128 a[208:211], v254 offset:13056
    v_mfma_f32_16x16x32_bf16 v[220:223], a[52:55], a[212:215], v[220:223]
    ds_read_b128 a[212:215], v254 offset:13120
    v_mfma_f32_16x16x32_bf16 v[220:223], a[56:59], a[216:219], v[220:223]
    ds_read_b128 a[216:219], v254 offset:13184
    v_mfma_f32_16x16x32_bf16 v[220:223], a[60:63], a[220:223], v[220:223]
    ds_read_b128 a[220:223], v254 offset:13248
    global_load_dwordx4 a[148:151], v250, s[36:37] offset:128 sc1
    s_waitcnt lgkmcnt(4)
    v_mfma_f32_16x16x32_bf16 v[192:195], a[96:99], a[224:227], v[192:195]
    global_load_dwordx4 a[152:155], v250, s[36:37] offset:256 sc1
    v_mfma_f32_16x16x32_bf16 v[192:195], a[100:103], a[228:231], v[192:195]
    v_mfma_f32_16x16x32_bf16 v[192:195], a[104:107], a[232:235], v[192:195]
    v_mfma_f32_16x16x32_bf16 v[192:195], a[108:111], a[236:239], v[192:195]
    v_mfma_f32_16x16x32_bf16 v[196:199], a[96:99], a[240:243], v[196:199]
    global_load_dwordx4 a[156:159], v250, s[36:37] offset:384 sc1
    v_mfma_f32_16x16x32_bf16 v[196:199], a[100:103], a[244:247], v[196:199]
    v_mfma_f32_16x16x32_bf16 v[196:199], a[104:107], a[248:251], v[196:199]
    s_nop 0
    v_cvt_pk_bf16_f32 v192, v192, v193
    v_cvt_pk_bf16_f32 v193, v194, v195
    v_mfma_f32_16x16x32_bf16 v[196:199], a[108:111], a[252:255], v[196:199]
    s_waitcnt vmcnt(8) lgkmcnt(0)
    ds_read_b128 a[112:115], v244 offset:13056
    ds_read_b128 a[116:119], v244 offset:13120
    global_load_dwordx4 a[160:163], v250, s[38:39] offset:-4096 sc1
    ds_read_b128 a[120:123], v244 offset:13184
    ds_read_b128 a[124:127], v244 offset:13248
    v_subrev_u32 v244, s80, v244
    v_sub_u32 v244, v244, v249
    v_subrev_u32 v249, s81, v245
    v_add_u32 v244, s80, v244
    v_cvt_pk_bf16_f32 v196, v196, v197
    v_cvt_pk_bf16_f32 v197, v198, v199
    global_load_dwordx4 a[164:167], v250, s[38:39] offset:-3968 sc1
    s_waitcnt lgkmcnt(2)
    v_mfma_f32_16x16x32_bf16 v[200:203], a[112:115], a[224:227], v[200:203]
    global_load_dwordx4 a[168:171], v250, s[38:39] offset:-3840 sc1
    ds_read_b128 a[224:227], v255 offset:8704
    v_mfma_f32_16x16x32_bf16 v[200:203], a[116:119], a[228:231], v[200:203]
    s_waitcnt lgkmcnt(1)
    ds_read_b128 a[228:231], v255 offset:8768
    v_mfma_f32_16x16x32_bf16 v[200:203], a[120:123], a[232:235], v[200:203]
    ds_read_b128 a[232:235], v255 offset:8832
    v_mfma_f32_16x16x32_bf16 v[200:203], a[124:127], a[236:239], v[200:203]
    ds_read_b128 a[236:239], v255 offset:8896
    v_mfma_f32_16x16x32_bf16 v[204:207], a[112:115], a[240:243], v[204:207]
    global_load_dwordx4 a[172:175], v250, s[38:39] offset:-3712 sc1
    ds_read_b128 a[240:243], v255 offset:13056
    v_mfma_f32_16x16x32_bf16 v[204:207], a[116:119], a[244:247], v[204:207]
    ds_read_b128 a[244:247], v255 offset:13120
    v_mfma_f32_16x16x32_bf16 v[204:207], a[120:123], a[248:251], v[204:207]
    v_cvt_pk_bf16_f32 v194, v200, v201
    v_cvt_pk_bf16_f32 v195, v202, v203
    v_mfma_f32_16x16x32_bf16 v[204:207], a[124:127], a[252:255], v[204:207]
    ds_write_b128 v245, v[192:195] offset:17408
    v_mfma_f32_16x16x32_bf16 v[208:211], a[64:67], a[192:195], v[208:211]
    global_load_dwordx4 a[176:179], v250, s[38:39] offset:0 sc1
    v_mfma_f32_16x16x32_bf16 v[208:211], a[68:71], a[196:199], v[208:211]
    v_mfma_f32_16x16x32_bf16 v[208:211], a[72:75], a[200:203], v[208:211]
    ds_read_b128 a[248:251], v255 offset:13184
    v_cvt_pk_bf16_f32 v198, v204, v205
    v_mfma_f32_16x16x32_bf16 v[208:211], a[76:79], a[204:207], v[208:211]
    ds_read_b128 a[252:255], v255 offset:13248
    v_cvt_pk_bf16_f32 v199, v206, v207
    v_mfma_f32_16x16x32_bf16 v[212:215], a[80:83], a[192:195], v[212:215]
    global_load_dwordx4 a[180:183], v250, s[38:39] offset:128 sc1
    ds_read_b128 a[192:195], v245 offset:17408
    v_mfma_f32_16x16x32_bf16 v[212:215], a[84:87], a[196:199], v[212:215]
    ds_write_b128 v245, v[196:199] offset:18432
    v_mfma_f32_16x16x32_bf16 v[212:215], a[88:91], a[200:203], v[212:215]
    v_mfma_f32_16x16x32_bf16 v[212:215], a[92:95], a[204:207], v[212:215]
    v_mfma_f32_16x16x32_bf16 v[216:219], a[64:67], a[208:211], v[216:219]
    global_load_dwordx4 a[184:187], v250, s[38:39] offset:256 sc1
    ds_read_b128 v[252:255], v251 offset:640
    v_mfma_f32_16x16x32_bf16 v[216:219], a[68:71], a[212:215], v[216:219]
    v_mfma_f32_16x16x32_bf16 v[216:219], a[72:75], a[216:219], v[216:219]
    v_mfma_f32_16x16x32_bf16 v[216:219], a[76:79], a[220:223], v[216:219]
    s_waitcnt vmcnt(13) lgkmcnt(1)
    s_barrier
    ds_read_b128 a[196:199], v246 offset:17408
    v_mfma_f32_16x16x32_bf16 v[220:223], a[80:83], a[208:211], v[220:223]
    global_load_dwordx4 a[188:191], v250, s[38:39] offset:384 sc1
    ds_read_b128 a[200:203], v247 offset:17408
    v_mfma_f32_16x16x32_bf16 v[220:223], a[84:87], a[212:215], v[220:223]
    ds_read_b128 a[204:207], v248 offset:17408
    ds_read_b128 a[208:211], v245 offset:18432
    v_mfma_f32_16x16x32_bf16 v[220:223], a[88:91], a[216:219], v[220:223]
    ds_read_b128 a[212:215], v246 offset:18432
    ds_read_b128 a[216:219], v247 offset:18432
    v_mfma_f32_16x16x32_bf16 v[220:223], a[92:95], a[220:223], v[220:223]
    ds_read_b128 a[220:223], v248 offset:18432
    v_mfma_f32_16x16x32_bf16 v[208:211], a[96:99], a[224:227], v[208:211]
    global_load_dwordx4 a[0:3], v250, s[40:41] offset:-4096 sc1
    v_mfma_f32_16x16x32_bf16 v[208:211], a[100:103], a[228:231], v[208:211]
    v_mfma_f32_16x16x32_bf16 v[208:211], a[104:107], a[232:235], v[208:211]
    v_mfma_f32_16x16x32_bf16 v[208:211], a[108:111], a[236:239], v[208:211]
    v_mfma_f32_16x16x32_bf16 v[212:215], a[112:115], a[224:227], v[212:215]
    global_load_dwordx4 a[4:7], v250, s[40:41] offset:-3968 sc1
    v_mfma_f32_16x16x32_bf16 v[212:215], a[116:119], a[228:231], v[212:215]
    v_mfma_f32_16x16x32_bf16 v[212:215], a[120:123], a[232:235], v[212:215]
    s_nop 0
    v_cvt_pk_bf16_f32 v208, v208, v209
    v_cvt_pk_bf16_f32 v209, v210, v211
    v_mfma_f32_16x16x32_bf16 v[212:215], a[124:127], a[236:239], v[212:215]
    v_mfma_f32_16x16x32_bf16 v[216:219], a[96:99], a[240:243], v[216:219]
    global_load_dwordx4 a[8:11], v250, s[40:41] offset:-3840 sc1
    v_mfma_f32_16x16x32_bf16 v[216:219], a[100:103], a[244:247], v[216:219]
    v_mfma_f32_16x16x32_bf16 v[216:219], a[104:107], a[248:251], v[216:219]
    s_nop 0
    v_cvt_pk_bf16_f32 v210, v212, v213
    v_cvt_pk_bf16_f32 v211, v214, v215
    v_mfma_f32_16x16x32_bf16 v[216:219], a[108:111], a[252:255], v[216:219]
    ds_write_b128 v245, v[208:211] offset:19456
    v_mfma_f32_16x16x32_bf16 v[220:223], a[112:115], a[240:243], v[220:223]
    global_load_dwordx4 a[12:15], v250, s[40:41] offset:-3712 sc1
    v_mfma_f32_16x16x32_bf16 v[220:223], a[116:119], a[244:247], v[220:223]
    v_mfma_f32_16x16x32_bf16 v[220:223], a[120:123], a[248:251], v[220:223]
    v_cvt_pk_bf16_f32 v216, v216, v217
    v_cvt_pk_bf16_f32 v217, v218, v219
    v_mfma_f32_16x16x32_bf16 v[220:223], a[124:127], a[252:255], v[220:223]
    ds_read_b128 a[224:227], v245 offset:19456
    v_mfma_f32_16x16x32_bf16 v[224:227], a[128:131], a[192:195], v[232:235]
    s_waitcnt vmcnt(12) lgkmcnt(2)
    global_load_dwordx4 a[16:19], v250, s[40:41] offset:0 sc1
    v_mfma_f32_16x16x32_bf16 v[224:227], a[132:135], a[196:199], v[224:227]
    v_mfma_f32_16x16x32_bf16 v[224:227], a[136:139], a[200:203], v[224:227]
    v_cvt_pk_bf16_f32 v218, v220, v221
    v_cvt_pk_bf16_f32 v219, v222, v223
    v_mfma_f32_16x16x32_bf16 v[224:227], a[140:143], a[204:207], v[224:227]
    ds_write_b128 v245, v[216:219] offset:20480
    v_mfma_f32_16x16x32_bf16 v[228:231], a[128:131], a[208:211], v[232:235]
    global_load_dwordx4 a[20:23], v250, s[40:41] offset:128 sc1
    v_mfma_f32_16x16x32_bf16 v[228:231], a[132:135], a[212:215], v[228:231]
    v_mfma_f32_16x16x32_bf16 v[228:231], a[136:139], a[216:219], v[228:231]
    ds_read_b128 v[232:235], v251 offset:144
    v_fma_f32 v224, v0, v224, v0
    v_mfma_f32_16x16x32_bf16 v[228:231], a[140:143], a[220:223], v[228:231]
    v_fma_f32 v225, v1, v225, v1
    v_cvt_pk_bf16_f32 v128, v224, v225
    v_mfma_f32_16x16x32_bf16 v[200:203], a[144:147], a[192:195], v[236:239]
    global_load_dwordx4 a[24:27], v250, s[40:41] offset:256 sc1
    v_fma_f32 v226, v2, v226, v2
    v_mfma_f32_16x16x32_bf16 v[200:203], a[148:151], a[196:199], v[200:203]
    v_fma_f32 v227, v3, v227, v3
    v_cvt_pk_bf16_f32 v129, v226, v227
    v_mfma_f32_16x16x32_bf16 v[200:203], a[152:155], a[200:203], v[200:203]
    v_fma_f32 v228, v32, v228, v32
    v_fma_f32 v229, v33, v229, v33
    v_mfma_f32_16x16x32_bf16 v[200:203], a[156:159], a[204:207], v[200:203]
    v_cvt_pk_bf16_f32 v144, v228, v229
    v_fma_f32 v230, v34, v230, v34
    v_mfma_f32_16x16x32_bf16 v[192:195], a[144:147], a[208:211], v[236:239]
    global_load_dwordx4 a[28:31], v250, s[40:41] offset:384 sc1
    v_fma_f32 v231, v35, v231, v35
    v_mfma_f32_16x16x32_bf16 v[192:195], a[148:151], a[212:215], v[192:195]
    ds_read_b128 v[236:239], v251 offset:256
    v_cvt_pk_bf16_f32 v145, v230, v231
    v_mfma_f32_16x16x32_bf16 v[192:195], a[152:155], a[216:219], v[192:195]
    v_fma_f32 v200, v4, v200, v4
    v_fma_f32 v201, v5, v201, v5
    v_mfma_f32_16x16x32_bf16 v[192:195], a[156:159], a[220:223], v[192:195]
    s_waitcnt vmcnt(13) lgkmcnt(1)
    v_cvt_pk_bf16_f32 v130, v200, v201
    v_fma_f32 v202, v6, v202, v6
    v_mfma_f32_16x16x32_bf16 v[204:207], a[160:163], a[192:195], v[240:243]
    global_load_dwordx4 a[32:35], v250, s[42:43] offset:-4096 sc1
    v_fma_f32 v203, v7, v203, v7
    v_mfma_f32_16x16x32_bf16 v[204:207], a[164:167], a[196:199], v[204:207]
    ds_read_b128 a[240:243], v245 offset:20480
    v_cvt_pk_bf16_f32 v131, v202, v203
    v_mfma_f32_16x16x32_bf16 v[204:207], a[168:171], a[200:203], v[204:207]
    s_waitcnt vmcnt(13)
    v_fma_f32 v192, v36, v192, v36
    v_fma_f32 v193, v37, v193, v37
    v_mfma_f32_16x16x32_bf16 v[204:207], a[172:175], a[204:207], v[204:207]
    v_cvt_pk_bf16_f32 v146, v192, v193
    v_fma_f32 v194, v38, v194, v38
    v_mfma_f32_16x16x32_bf16 v[196:199], a[160:163], a[208:211], v[240:243]
    global_load_dwordx4 a[36:39], v250, s[42:43] offset:-3968 sc1
    v_fma_f32 v195, v39, v195, v39
    v_mfma_f32_16x16x32_bf16 v[196:199], a[164:167], a[212:215], v[196:199]
    ds_read_b128 v[240:243], v251 offset:272
    v_cvt_pk_bf16_f32 v147, v194, v195
    v_mfma_f32_16x16x32_bf16 v[196:199], a[168:171], a[216:219], v[196:199]
    v_fma_f32 v204, v8, v204, v8
    v_fma_f32 v205, v9, v205, v9
    v_mfma_f32_16x16x32_bf16 v[196:199], a[172:175], a[220:223], v[196:199]
    s_waitcnt vmcnt(13) lgkmcnt(2)
    v_cvt_pk_bf16_f32 v132, v204, v205
    v_fma_f32 v206, v10, v206, v10
    v_mfma_f32_16x16x32_bf16 v[212:215], a[176:179], a[192:195], v[232:235]
    s_waitcnt vmcnt(12)
    global_load_dwordx4 a[40:43], v250, s[42:43] offset:-3840 sc1
    v_fma_f32 v207, v11, v207, v11
    v_mfma_f32_16x16x32_bf16 v[212:215], a[180:183], a[196:199], v[212:215]
    s_waitcnt vmcnt(12) lgkmcnt(1)
    v_cvt_pk_bf16_f32 v133, v206, v207
    v_mfma_f32_16x16x32_bf16 v[212:215], a[184:187], a[200:203], v[212:215]
    s_waitcnt vmcnt(11)
    s_barrier
    ds_read_b128 a[228:231], v246 offset:19456
    v_mfma_f32_16x16x32_bf16 v[212:215], a[188:191], a[204:207], v[212:215]
    ds_write_b128 v245, v[128:131] offset:0
    v_mfma_f32_16x16x32_bf16 v[208:211], a[176:179], a[208:211], v[232:235]
    global_load_dwordx4 a[44:47], v250, s[42:43] offset:-3712 sc1
    v_fma_f32 v196, v40, v196, v40
    v_mfma_f32_16x16x32_bf16 v[208:211], a[180:183], a[212:215], v[208:211]
    ds_write_b128 v245, v[144:147] offset:4096
    v_mfma_f32_16x16x32_bf16 v[208:211], a[184:187], a[216:219], v[208:211]
    v_fma_f32 v197, v41, v197, v41
    v_cvt_pk_bf16_f32 v148, v196, v197
    v_mfma_f32_16x16x32_bf16 v[208:211], a[188:191], a[220:223], v[208:211]
    s_waitcnt vmcnt(11) lgkmcnt(3)
    v_fma_f32 v212, v12, v212, v12
    v_fma_f32 v213, v13, v213, v13
    v_mfma_f32_16x16x32_bf16 v[220:223], a[0:3], a[192:195], v[236:239]
    global_load_dwordx4 a[48:51], v250, s[42:43] offset:0 sc1
    ds_read_b128 v[232:235], v251 offset:384
    ds_read_b128 a[232:235], v247 offset:19456
    v_cvt_pk_bf16_f32 v134, v212, v213
    v_fma_f32 v214, v14, v214, v14
    v_fma_f32 v215, v15, v215, v15
    s_waitcnt vmcnt(11) lgkmcnt(4)
    v_cvt_pk_bf16_f32 v135, v214, v215
    v_fma_f32 v198, v42, v198, v42
    v_fma_f32 v199, v43, v199, v43
    v_cvt_pk_bf16_f32 v149, v198, v199
    v_mfma_f32_16x16x32_bf16 v[220:223], a[4:7], a[196:199], v[220:223]
    ds_write_b128 v245, v[132:135] offset:1024
    global_load_dwordx4 a[52:55], v250, s[42:43] offset:128 sc1
    ds_read_b128 a[236:239], v248 offset:19456
    ds_read_b128 a[244:247], v246 offset:20480
    ds_read_b128 a[248:251], v247 offset:20480
    ds_read_b128 a[252:255], v248 offset:20480
    v_fma_f32 v208, v44, v208, v44
    v_fma_f32 v209, v45, v209, v45
    v_cvt_pk_bf16_f32 v150, v208, v209
    s_waitcnt vmcnt(11) lgkmcnt(7)
    v_fma_f32 v210, v46, v210, v46
    v_fma_f32 v211, v47, v211, v47
    v_cvt_pk_bf16_f32 v151, v210, v211
    v_mfma_f32_16x16x32_bf16 v[220:223], a[8:11], a[200:203], v[220:223]
    ds_write_b128 v245, v[148:151] offset:5120
    global_load_dwordx4 a[56:59], v250, s[42:43] offset:256 sc1
    s_waitcnt vmcnt(11) lgkmcnt(6)
    v_mfma_f32_16x16x32_bf16 v[220:223], a[12:15], a[204:207], v[220:223]
    v_mfma_f32_16x16x32_bf16 v[216:219], a[0:3], a[208:211], v[236:239]
    global_load_dwordx4 a[60:63], v250, s[42:43] offset:384 sc1
    v_mfma_f32_16x16x32_bf16 v[216:219], a[4:7], a[212:215], v[216:219]
    ds_read_b128 v[236:239], v251 offset:400
    v_add_u32 v250, 0x20000, v250
    v_mfma_f32_16x16x32_bf16 v[216:219], a[8:11], a[216:219], v[216:219]
    v_fma_f32 v220, v16, v220, v16
    v_fma_f32 v221, v17, v221, v17
    v_mfma_f32_16x16x32_bf16 v[216:219], a[12:15], a[220:223], v[216:219]
    s_waitcnt vmcnt(11) lgkmcnt(1)
    v_cvt_pk_bf16_f32 v136, v220, v221
    v_fma_f32 v222, v18, v222, v18
    v_mfma_f32_16x16x32_bf16 v[224:227], a[16:19], a[192:195], v[240:243]
    global_load_dwordx4 a[64:67], v250, s[36:37] offset:-4096 sc1
    v_fma_f32 v223, v19, v223, v19
    v_cvt_pk_bf16_f32 v137, v222, v223
    s_waitcnt vmcnt(11)
    v_fma_f32 v216, v48, v216, v48
    v_fma_f32 v217, v49, v217, v49
    v_cvt_pk_bf16_f32 v152, v216, v217
    v_fma_f32 v218, v50, v218, v50
    v_mfma_f32_16x16x32_bf16 v[224:227], a[20:23], a[196:199], v[224:227]
    v_fma_f32 v219, v51, v219, v51
    v_cvt_pk_bf16_f32 v153, v218, v219
    global_load_dwordx4 a[68:71], v250, s[36:37] offset:-3968 sc1
    s_waitcnt vmcnt(11) lgkmcnt(0)
    v_mfma_f32_16x16x32_bf16 v[224:227], a[24:27], a[200:203], v[224:227]
    global_load_dwordx4 a[72:75], v250, s[36:37] offset:-3840 sc1
    s_waitcnt vmcnt(11)
    v_mfma_f32_16x16x32_bf16 v[224:227], a[28:31], a[204:207], v[224:227]
    v_mfma_f32_16x16x32_bf16 v[228:231], a[16:19], a[208:211], v[240:243]
    global_load_dwordx4 a[76:79], v250, s[36:37] offset:-3712 sc1
    v_mfma_f32_16x16x32_bf16 v[228:231], a[20:23], a[212:215], v[228:231]
    ds_read_b128 v[240:243], v251 offset:0
    v_mfma_f32_16x16x32_bf16 v[228:231], a[24:27], a[216:219], v[228:231]
    v_fma_f32 v224, v20, v224, v20
    v_fma_f32 v225, v21, v225, v21
    v_mfma_f32_16x16x32_bf16 v[228:231], a[28:31], a[220:223], v[228:231]
    s_waitcnt vmcnt(11)
    v_cvt_pk_bf16_f32 v138, v224, v225
    v_fma_f32 v226, v22, v226, v22
    v_mfma_f32_16x16x32_bf16 v[200:203], a[32:35], a[192:195], v[232:235]
    global_load_dwordx4 a[80:83], v250, s[36:37] offset:0 sc1
    v_fma_f32 v227, v23, v227, v23
    v_cvt_pk_bf16_f32 v139, v226, v227
    s_waitcnt vmcnt(11)
    v_fma_f32 v228, v52, v228, v52
    v_fma_f32 v229, v53, v229, v53
    v_cvt_pk_bf16_f32 v154, v228, v229
    v_fma_f32 v230, v54, v230, v54
    v_mfma_f32_16x16x32_bf16 v[200:203], a[36:39], a[196:199], v[200:203]
    v_fma_f32 v231, v55, v231, v55
    v_cvt_pk_bf16_f32 v155, v230, v231
    global_load_dwordx4 a[84:87], v250, s[36:37] offset:128 sc1
    ds_write_b128 v245, v[136:139] offset:2048
    ds_write_b128 v245, v[152:155] offset:6144
    s_waitcnt vmcnt(11) lgkmcnt(2)
    v_mfma_f32_16x16x32_bf16 v[200:203], a[40:43], a[200:203], v[200:203]
    global_load_dwordx4 a[88:91], v250, s[36:37] offset:256 sc1
    s_waitcnt vmcnt(11)
    v_mfma_f32_16x16x32_bf16 v[200:203], a[44:47], a[204:207], v[200:203]
    v_mfma_f32_16x16x32_bf16 v[192:195], a[32:35], a[208:211], v[232:235]
    global_load_dwordx4 a[92:95], v250, s[36:37] offset:384 sc1
    v_mfma_f32_16x16x32_bf16 v[192:195], a[36:39], a[212:215], v[192:195]
    ds_read_b128 v[232:235], v251 offset:16
    v_mfma_f32_16x16x32_bf16 v[192:195], a[40:43], a[216:219], v[192:195]
    v_fma_f32 v200, v24, v200, v24
    v_fma_f32 v201, v25, v201, v25
    v_mfma_f32_16x16x32_bf16 v[192:195], a[44:47], a[220:223], v[192:195]
    s_waitcnt vmcnt(11) lgkmcnt(1)
    v_cvt_pk_bf16_f32 v140, v200, v201
    v_fma_f32 v202, v26, v202, v26
    v_mfma_f32_16x16x32_bf16 v[204:207], a[48:51], a[192:195], v[236:239]
    global_load_dwordx4 a[96:99], v250, s[38:39] offset:-4096 sc1
    v_fma_f32 v203, v27, v203, v27
    v_cvt_pk_bf16_f32 v141, v202, v203
    s_waitcnt vmcnt(11)
    v_fma_f32 v192, v56, v192, v56
    v_fma_f32 v193, v57, v193, v57
    v_cvt_pk_bf16_f32 v156, v192, v193
    v_fma_f32 v194, v58, v194, v58
    v_mfma_f32_16x16x32_bf16 v[204:207], a[52:55], a[196:199], v[204:207]
    v_fma_f32 v195, v59, v195, v59
    v_cvt_pk_bf16_f32 v157, v194, v195
    global_load_dwordx4 a[100:103], v250, s[38:39] offset:-3968 sc1
    s_waitcnt vmcnt(11) lgkmcnt(0)
    v_mfma_f32_16x16x32_bf16 v[204:207], a[56:59], a[200:203], v[204:207]
    global_load_dwordx4 a[104:107], v250, s[38:39] offset:-3840 sc1
    s_waitcnt vmcnt(11)
    v_mfma_f32_16x16x32_bf16 v[204:207], a[60:63], a[204:207], v[204:207]
    v_mfma_f32_16x16x32_bf16 v[196:199], a[48:51], a[208:211], v[236:239]
    global_load_dwordx4 a[108:111], v250, s[38:39] offset:-3712 sc1
    v_mfma_f32_16x16x32_bf16 v[196:199], a[52:55], a[212:215], v[196:199]
    ds_read_b128 v[236:239], v251 offset:128
    v_mfma_f32_16x16x32_bf16 v[196:199], a[56:59], a[216:219], v[196:199]
    v_fma_f32 v204, v28, v204, v28
    v_fma_f32 v205, v29, v205, v29
    v_mfma_f32_16x16x32_bf16 v[196:199], a[60:63], a[220:223], v[196:199]
    v_cvt_pk_bf16_f32 v142, v204, v205
    v_fma_f32 v206, v30, v206, v30
    v_mfma_f32_16x16x32_bf16 v[212:215], a[128:131], a[224:227], v[240:243]
    global_load_dwordx4 a[112:115], v250, s[38:39] offset:0 sc1
    v_fma_f32 v207, v31, v207, v31
    v_mfma_f32_16x16x32_bf16 v[212:215], a[132:135], a[228:231], v[212:215]
    v_cvt_pk_bf16_f32 v143, v206, v207
    v_mfma_f32_16x16x32_bf16 v[212:215], a[136:139], a[232:235], v[212:215]
    ds_write_b128 v245, v[140:143] offset:3072
    v_mfma_f32_16x16x32_bf16 v[212:215], a[140:143], a[236:239], v[212:215]
    v_fma_f32 v196, v60, v196, v60
    v_fma_f32 v197, v61, v197, v61
    v_mfma_f32_16x16x32_bf16 v[208:211], a[128:131], a[240:243], v[240:243]
    global_load_dwordx4 a[116:119], v250, s[38:39] offset:128 sc1
    v_cvt_pk_bf16_f32 v158, v196, v197
    v_mfma_f32_16x16x32_bf16 v[208:211], a[132:135], a[244:247], v[208:211]
    ds_read_b128 v[240:243], v251 offset:144
    v_fma_f32 v198, v62, v198, v62
    v_mfma_f32_16x16x32_bf16 v[208:211], a[136:139], a[248:251], v[208:211]
    v_fma_f32 v199, v63, v199, v63
    v_cvt_pk_bf16_f32 v159, v198, v199
    v_mfma_f32_16x16x32_bf16 v[208:211], a[140:143], a[252:255], v[208:211]
    ds_write_b128 v245, v[156:159] offset:7168
    v_mfma_f32_16x16x32_bf16 v[220:223], a[144:147], a[224:227], v[232:235]
    global_load_dwordx4 a[120:123], v250, s[38:39] offset:256 sc1
    v_fma_f32 v212, v64, v212, v64
    v_mfma_f32_16x16x32_bf16 v[220:223], a[148:151], a[228:231], v[220:223]
    v_fma_f32 v213, v65, v213, v65
    v_cvt_pk_bf16_f32 v160, v212, v213
    v_mfma_f32_16x16x32_bf16 v[220:223], a[152:155], a[232:235], v[220:223]
    v_fma_f32 v214, v66, v214, v66
    v_fma_f32 v215, v67, v215, v67
    v_mfma_f32_16x16x32_bf16 v[220:223], a[156:159], a[236:239], v[220:223]
    v_cvt_pk_bf16_f32 v161, v214, v215
    v_fma_f32 v208, v96, v208, v96
    v_mfma_f32_16x16x32_bf16 v[216:219], a[144:147], a[240:243], v[232:235]
    global_load_dwordx4 a[124:127], v250, s[38:39] offset:384 sc1
    v_fma_f32 v209, v97, v209, v97
    v_mfma_f32_16x16x32_bf16 v[216:219], a[148:151], a[244:247], v[216:219]
    s_waitcnt vmcnt(13) lgkmcnt(0)
    s_barrier
    ds_read_b128 a[192:195], v246 offset:0
    v_mfma_f32_16x16x32_bf16 v[216:219], a[152:155], a[248:251], v[216:219]
    ds_read_b128 a[196:199], v246 offset:1024
    ds_read_b128 a[200:203], v246 offset:2048
    v_mfma_f32_16x16x32_bf16 v[216:219], a[156:159], a[252:255], v[216:219]
    v_cvt_pk_bf16_f32 v176, v208, v209
    v_fma_f32 v210, v98, v210, v98
    v_mfma_f32_16x16x32_bf16 v[224:227], a[64:67], v[128:131], 0
    global_load_dwordx4 a[128:131], v250, s[40:41] offset:-4096 sc1
    v_fma_f32 v211, v99, v211, v99
    v_mfma_f32_16x16x32_bf16 v[224:227], a[68:71], v[132:135], v[224:227]
    ds_read_b128 a[204:207], v246 offset:3072
    v_cvt_pk_bf16_f32 v177, v210, v211
    v_mfma_f32_16x16x32_bf16 v[224:227], a[72:75], v[136:139], v[224:227]
    s_waitcnt vmcnt(13)
    ds_read_b128 v[232:235], v251 offset:256
    v_fma_f32 v220, v68, v220, v68
    v_mfma_f32_16x16x32_bf16 v[224:227], a[76:79], v[140:143], v[224:227]
    v_fma_f32 v221, v69, v221, v69
    v_cvt_pk_bf16_f32 v162, v220, v221
    v_mfma_f32_16x16x32_bf16 v[228:231], a[160:163], a[224:227], v[236:239]
    global_load_dwordx4 a[132:135], v250, s[40:41] offset:-3968 sc1
    v_fma_f32 v222, v70, v222, v70
    v_mfma_f32_16x16x32_bf16 v[228:231], a[164:167], a[228:231], v[228:231]
    v_fma_f32 v223, v71, v223, v71
    v_cvt_pk_bf16_f32 v163, v222, v223
    v_mfma_f32_16x16x32_bf16 v[228:231], a[168:171], a[232:235], v[228:231]
    ds_read_b128 a[208:211], v246 offset:4096
    ds_read_b128 a[212:215], v246 offset:5120
    v_mfma_f32_16x16x32_bf16 v[228:231], a[172:175], a[236:239], v[228:231]
L_st1:
    s_cbranch_execz L_wret
    s_waitcnt vmcnt(13) lgkmcnt(4)
    v_fma_f32 v216, v100, v216, v100
    v_fma_f32 v217, v101, v217, v101
    v_mfma_f32_16x16x32_bf16 v[200:203], a[80:83], v[128:131], 0
    s_waitcnt vmcnt(12)
    global_load_dwordx4 a[136:139], v250, s[40:41] offset:-3840 sc1
    ds_read_b128 a[216:219], v246 offset:6144
    v_mfma_f32_16x16x32_bf16 v[200:203], a[84:87], v[132:135], v[200:203]
    s_waitcnt vmcnt(12) lgkmcnt(4)
    v_cvt_pk_bf16_f32 v178, v216, v217
    v_fma_f32 v218, v102, v218, v102
    v_mfma_f32_16x16x32_bf16 v[200:203], a[88:91], v[136:139], v[200:203]
    s_waitcnt vmcnt(11) lgkmcnt(3)
    v_fma_f32 v219, v103, v219, v103
    v_cvt_pk_bf16_f32 v179, v218, v219
    v_mfma_f32_16x16x32_bf16 v[200:203], a[92:95], v[140:143], v[200:203]
    ds_read_b128 a[220:223], v246 offset:7168
    v_fma_f32 v228, v72, v228, v72
    v_mfma_f32_16x16x32_bf16 v[192:195], a[160:163], a[240:243], v[236:239]
    global_load_dwordx4 a[140:143], v250, s[40:41] offset:-3712 sc1
    v_fma_f32 v229, v73, v229, v73
    v_mfma_f32_16x16x32_bf16 v[192:195], a[164:167], a[244:247], v[192:195]
    ds_read_b128 v[236:239], v251 offset:272
    v_cvt_pk_bf16_f32 v164, v228, v229
    v_mfma_f32_16x16x32_bf16 v[192:195], a[168:171], a[248:251], v[192:195]
    v_fma_f32 v230, v74, v230, v74
    v_fma_f32 v231, v75, v231, v75
    v_mfma_f32_16x16x32_bf16 v[192:195], a[172:175], a[252:255], v[192:195]
    v_cvt_pk_bf16_f32 v165, v230, v231
    v_mfma_f32_16x16x32_bf16 v[204:207], a[64:67], v[144:147], 0
    global_load_dwordx4 a[144:147], v250, s[40:41] offset:0 sc1
    v_mfma_f32_16x16x32_bf16 v[204:207], a[68:71], v[148:151], v[204:207]
    ds_write_b128 v245, v[160:163] offset:8704
    v_mfma_f32_16x16x32_bf16 v[204:207], a[72:75], v[152:155], v[204:207]
    v_fma_f32 v192, v104, v192, v104
    v_fma_f32 v193, v105, v193, v105
    v_mfma_f32_16x16x32_bf16 v[204:207], a[76:79], v[156:159], v[204:207]
    v_cvt_pk_bf16_f32 v180, v192, v193
    v_fma_f32 v194, v106, v194, v106
    v_mfma_f32_16x16x32_bf16 v[196:199], a[176:179], a[224:227], v[240:243]
    global_load_dwordx4 a[148:151], v250, s[40:41] offset:128 sc1
    v_fma_f32 v195, v107, v195, v107
    v_mfma_f32_16x16x32_bf16 v[196:199], a[180:183], a[228:231], v[196:199]
    v_cvt_pk_bf16_f32 v181, v194, v195
    v_mfma_f32_16x16x32_bf16 v[196:199], a[184:187], a[232:235], v[196:199]
    ds_write_b128 v245, v[176:179] offset:12800
    v_mfma_f32_16x16x32_bf16 v[196:199], a[188:191], a[236:239], v[196:199]
    v_mfma_f32_16x16x32_bf16 v[212:215], a[80:83], v[144:147], 0
    global_load_dwordx4 a[152:155], v250, s[40:41] offset:256 sc1
    v_mfma_f32_16x16x32_bf16 v[212:215], a[84:87], v[148:151], v[212:215]
    v_mfma_f32_16x16x32_bf16 v[212:215], a[88:91], v[152:155], v[212:215]
    s_nop 0
    v_fma_f32 v196, v76, v196, v76
    v_fma_f32 v197, v77, v197, v77
    v_mfma_f32_16x16x32_bf16 v[212:215], a[92:95], v[156:159], v[212:215]
    v_cvt_pk_bf16_f32 v166, v196, v197
    v_fma_f32 v198, v78, v198, v78
    v_mfma_f32_16x16x32_bf16 v[208:211], a[176:179], a[240:243], v[240:243]
    global_load_dwordx4 a[156:159], v250, s[40:41] offset:384 sc1
    v_fma_f32 v199, v79, v199, v79
    v_mfma_f32_16x16x32_bf16 v[208:211], a[180:183], a[244:247], v[208:211]
    ds_read_b128 v[240:243], v251 offset:384
    v_cvt_pk_bf16_f32 v167, v198, v199
    v_mfma_f32_16x16x32_bf16 v[208:211], a[184:187], a[248:251], v[208:211]
    ds_write_b128 v245, v[164:167] offset:9728
    v_mfma_f32_16x16x32_bf16 v[208:211], a[188:191], a[252:255], v[208:211]
    s_waitcnt vmcnt(13) lgkmcnt(2)
    v_mfma_f32_16x16x32_bf16 v[224:227], a[96:99], a[192:195], v[224:227]
    global_load_dwordx4 a[160:163], v250, s[42:43] offset:-4096 sc1
    v_mfma_f32_16x16x32_bf16 v[224:227], a[100:103], a[196:199], v[224:227]
    v_mfma_f32_16x16x32_bf16 v[224:227], a[104:107], a[200:203], v[224:227]
    s_waitcnt vmcnt(13)
    v_fma_f32 v208, v108, v208, v108
    v_fma_f32 v209, v109, v209, v109
    v_mfma_f32_16x16x32_bf16 v[224:227], a[108:111], a[204:207], v[224:227]
    v_cvt_pk_bf16_f32 v182, v208, v209
    v_fma_f32 v210, v110, v210, v110
    v_mfma_f32_16x16x32_bf16 v[220:223], a[0:3], a[224:227], v[232:235]
    global_load_dwordx4 a[164:167], v250, s[42:43] offset:-3968 sc1
    v_fma_f32 v211, v111, v211, v111
    v_mfma_f32_16x16x32_bf16 v[220:223], a[4:7], a[228:231], v[220:223]
    v_cvt_pk_bf16_f32 v183, v210, v211
    v_mfma_f32_16x16x32_bf16 v[220:223], a[8:11], a[232:235], v[220:223]
    ds_write_b128 v245, v[180:183] offset:13824
    v_mfma_f32_16x16x32_bf16 v[220:223], a[12:15], a[236:239], v[220:223]
    s_waitcnt vmcnt(13) lgkmcnt(1)
    v_mfma_f32_16x16x32_bf16 v[200:203], a[112:115], a[192:195], v[200:203]
    s_waitcnt vmcnt(12)
    global_load_dwordx4 a[168:171], v250, s[42:43] offset:-3840 sc1
    v_mfma_f32_16x16x32_bf16 v[200:203], a[116:119], a[196:199], v[200:203]
    s_waitcnt vmcnt(12)
    ds_read_b128 a[192:195], v247 offset:0
    ds_read_b128 a[196:199], v247 offset:1024
    v_mfma_f32_16x16x32_bf16 v[200:203], a[120:123], a[200:203], v[200:203]
    s_waitcnt vmcnt(11)
    ds_read_b128 a[200:203], v247 offset:2048
    v_fma_f32 v220, v80, v220, v80
    v_mfma_f32_16x16x32_bf16 v[200:203], a[124:127], a[204:207], v[200:203]
    ds_read_b128 a[204:207], v247 offset:3072
    v_fma_f32 v221, v81, v221, v81
    v_mfma_f32_16x16x32_bf16 v[216:219], a[0:3], a[240:243], v[232:235]
    global_load_dwordx4 a[172:175], v250, s[42:43] offset:-3712 sc1
    v_cvt_pk_bf16_f32 v168, v220, v221
    v_mfma_f32_16x16x32_bf16 v[216:219], a[4:7], a[244:247], v[216:219]
    ds_read_b128 v[232:235], v251 offset:400
    v_fma_f32 v222, v82, v222, v82
    v_mfma_f32_16x16x32_bf16 v[216:219], a[8:11], a[248:251], v[216:219]
    v_fma_f32 v223, v83, v223, v83
    v_cvt_pk_bf16_f32 v169, v222, v223
    v_mfma_f32_16x16x32_bf16 v[216:219], a[12:15], a[252:255], v[216:219]
    v_mfma_f32_16x16x32_bf16 v[204:207], a[96:99], a[208:211], v[204:207]
    global_load_dwordx4 a[176:179], v250, s[42:43] offset:0 sc1
    v_mfma_f32_16x16x32_bf16 v[204:207], a[100:103], a[212:215], v[204:207]
    v_mfma_f32_16x16x32_bf16 v[204:207], a[104:107], a[216:219], v[204:207]
    s_nop 0
    v_fma_f32 v216, v112, v216, v112
    v_fma_f32 v217, v113, v217, v113
    v_mfma_f32_16x16x32_bf16 v[204:207], a[108:111], a[220:223], v[204:207]
    v_cvt_pk_bf16_f32 v184, v216, v217
    v_fma_f32 v218, v114, v218, v114
    v_mfma_f32_16x16x32_bf16 v[228:231], a[16:19], a[224:227], v[236:239]
    global_load_dwordx4 a[180:183], v250, s[42:43] offset:128 sc1
    v_fma_f32 v219, v115, v219, v115
    v_mfma_f32_16x16x32_bf16 v[228:231], a[20:23], a[228:231], v[228:231]
    v_cvt_pk_bf16_f32 v185, v218, v219
    v_mfma_f32_16x16x32_bf16 v[228:231], a[24:27], a[232:235], v[228:231]
    v_mfma_f32_16x16x32_bf16 v[228:231], a[28:31], a[236:239], v[228:231]
    v_mfma_f32_16x16x32_bf16 v[212:215], a[112:115], a[208:211], v[212:215]
    global_load_dwordx4 a[184:187], v250, s[42:43] offset:256 sc1
    ds_read_b128 a[208:211], v247 offset:4096
    v_mfma_f32_16x16x32_bf16 v[212:215], a[116:119], a[212:215], v[212:215]
    ds_read_b128 a[212:215], v247 offset:5120
    v_mfma_f32_16x16x32_bf16 v[212:215], a[120:123], a[216:219], v[212:215]
    ds_read_b128 a[216:219], v247 offset:6144
    v_fma_f32 v228, v84, v228, v84
    v_mfma_f32_16x16x32_bf16 v[212:215], a[124:127], a[220:223], v[212:215]
    ds_read_b128 a[220:223], v247 offset:7168
    v_fma_f32 v229, v85, v229, v85
    v_mfma_f32_16x16x32_bf16 v[192:195], a[16:19], a[240:243], v[236:239]
    global_load_dwordx4 a[188:191], v250, s[42:43] offset:384 sc1
    v_cvt_pk_bf16_f32 v170, v228, v229
    v_mfma_f32_16x16x32_bf16 v[192:195], a[20:23], a[244:247], v[192:195]
    v_add_u32 v250, 0x20000, v250
    v_fma_f32 v230, v86, v230, v86
    v_mfma_f32_16x16x32_bf16 v[192:195], a[24:27], a[248:251], v[192:195]
    v_fma_f32 v231, v87, v231, v87
    v_cvt_pk_bf16_f32 v171, v230, v231
    v_mfma_f32_16x16x32_bf16 v[192:195], a[28:31], a[252:255], v[192:195]
    s_waitcnt vmcnt(13) lgkmcnt(4)
    ds_write_b128 v245, v[168:171] offset:10752
    v_mfma_f32_16x16x32_bf16 v[224:227], a[128:131], a[192:195], v[224:227]
    global_load_dwordx4 a[0:3], v250, s[36:37] offset:-4096 sc1
    v_mfma_f32_16x16x32_bf16 v[224:227], a[132:135], a[196:199], v[224:227]
    v_mfma_f32_16x16x32_bf16 v[224:227], a[136:139], a[200:203], v[224:227]
    s_waitcnt vmcnt(13) lgkmcnt(2)
    v_fma_f32 v192, v116, v192, v116
    v_fma_f32 v193, v117, v193, v117
    v_mfma_f32_16x16x32_bf16 v[224:227], a[140:143], a[204:207], v[224:227]
    v_cvt_pk_bf16_f32 v186, v192, v193
    v_fma_f32 v194, v118, v194, v118
    v_mfma_f32_16x16x32_bf16 v[196:199], a[32:35], a[224:227], v[240:243]
    global_load_dwordx4 a[4:7], v250, s[36:37] offset:-3968 sc1
    v_fma_f32 v195, v119, v195, v119
    v_mfma_f32_16x16x32_bf16 v[196:199], a[36:39], a[228:231], v[196:199]
    ds_read_b128 v[236:239], v251 offset:512
    v_cvt_pk_bf16_f32 v187, v194, v195
    v_mfma_f32_16x16x32_bf16 v[196:199], a[40:43], a[232:235], v[196:199]
    ds_write_b128 v245, v[184:187] offset:14848
    v_mfma_f32_16x16x32_bf16 v[196:199], a[44:47], a[236:239], v[196:199]
    s_waitcnt vmcnt(13) lgkmcnt(2)
    v_mfma_f32_16x16x32_bf16 v[200:203], a[144:147], a[192:195], v[200:203]
    s_waitcnt vmcnt(12)
    global_load_dwordx4 a[8:11], v250, s[36:37] offset:-3840 sc1
    v_mfma_f32_16x16x32_bf16 v[200:203], a[148:151], a[196:199], v[200:203]
    s_waitcnt vmcnt(12)
    ds_read_b128 a[192:195], v248 offset:0
    ds_read_b128 a[196:199], v248 offset:1024
    v_mfma_f32_16x16x32_bf16 v[200:203], a[152:155], a[200:203], v[200:203]
    s_waitcnt vmcnt(11)
    ds_read_b128 a[200:203], v248 offset:2048
    v_fma_f32 v196, v88, v196, v88
    v_mfma_f32_16x16x32_bf16 v[200:203], a[156:159], a[204:207], v[200:203]
    ds_read_b128 a[204:207], v248 offset:3072
    v_fma_f32 v197, v89, v197, v89
    v_mfma_f32_16x16x32_bf16 v[208:211], a[32:35], a[240:243], v[240:243]
    global_load_dwordx4 a[12:15], v250, s[36:37] offset:-3712 sc1
    v_cvt_pk_bf16_f32 v172, v196, v197
    v_mfma_f32_16x16x32_bf16 v[208:211], a[36:39], a[244:247], v[208:211]
    v_fma_f32 v198, v90, v198, v90
    v_fma_f32 v199, v91, v199, v91
    v_mfma_f32_16x16x32_bf16 v[208:211], a[40:43], a[248:251], v[208:211]
    v_cvt_pk_bf16_f32 v173, v198, v199
    v_lshlrev_b32 v240, 16, v128
    v_mfma_f32_16x16x32_bf16 v[208:211], a[44:47], a[252:255], v[208:211]
    v_and_b32 v241, s84, v128
    v_lshlrev_b32 v242, 16, v129
    v_mfma_f32_16x16x32_bf16 v[204:207], a[128:131], a[208:211], v[204:207]
    global_load_dwordx4 a[16:19], v250, s[36:37] offset:0 sc1
    v_and_b32 v243, s84, v129
    v_mfma_f32_16x16x32_bf16 v[204:207], a[132:135], a[212:215], v[204:207]
    v_mfma_f32_16x16x32_bf16 v[204:207], a[136:139], a[216:219], v[204:207]
    v_fma_f32 v208, v120, v208, v120
    v_fma_f32 v209, v121, v209, v121
    v_mfma_f32_16x16x32_bf16 v[204:207], a[140:143], a[220:223], v[204:207]
    v_cvt_pk_bf16_f32 v188, v208, v209
    v_fma_f32 v210, v122, v210, v122
    v_mfma_f32_16x16x32_bf16 v[220:223], a[48:51], a[224:227], v[232:235]
    global_load_dwordx4 a[20:23], v250, s[36:37] offset:128 sc1
    ds_read_b128 a[224:227], v248 offset:4096
    v_mfma_f32_16x16x32_bf16 v[220:223], a[52:55], a[228:231], v[220:223]
    ds_read_b128 a[228:231], v248 offset:5120
    v_fma_f32 v211, v123, v211, v123
    v_mfma_f32_16x16x32_bf16 v[220:223], a[56:59], a[232:235], v[220:223]
    ds_read_b128 a[232:235], v248 offset:6144
    v_cvt_pk_bf16_f32 v189, v210, v211
    v_mfma_f32_16x16x32_bf16 v[220:223], a[60:63], a[236:239], v[220:223]
    ds_read_b128 a[236:239], v248 offset:7168
    v_mfma_f32_16x16x32_bf16 v[212:215], a[144:147], a[208:211], v[212:215]
    global_load_dwordx4 a[24:27], v250, s[36:37] offset:256 sc1
    v_mfma_f32_16x16x32_bf16 v[212:215], a[148:151], a[212:215], v[212:215]
    v_mfma_f32_16x16x32_bf16 v[212:215], a[152:155], a[216:219], v[212:215]
    v_fma_f32 v220, v92, v220, v92
    v_fma_f32 v221, v93, v221, v93
    v_mfma_f32_16x16x32_bf16 v[212:215], a[156:159], a[220:223], v[212:215]
    v_cvt_pk_bf16_f32 v174, v220, v221
    v_fma_f32 v222, v94, v222, v94
    v_mfma_f32_16x16x32_bf16 v[216:219], a[48:51], a[240:243], v[232:235]
    global_load_dwordx4 a[28:31], v250, s[36:37] offset:384 sc1
    v_fma_f32 v223, v95, v223, v95
    v_mfma_f32_16x16x32_bf16 v[216:219], a[52:55], a[244:247], v[216:219]
    ds_read_b128 v[232:235], v251 offset:528
    v_cvt_pk_bf16_f32 v175, v222, v223
    v_mfma_f32_16x16x32_bf16 v[216:219], a[56:59], a[248:251], v[216:219]
    ds_write_b128 v245, v[172:175] offset:11776
    v_mfma_f32_16x16x32_bf16 v[216:219], a[60:63], a[252:255], v[216:219]
    s_waitcnt vmcnt(13) lgkmcnt(2)
    v_mfma_f32_16x16x32_bf16 v[224:227], a[160:163], a[192:195], v[224:227]
    global_load_dwordx4 a[32:35], v250, s[38:39] offset:-4096 sc1
    v_mfma_f32_16x16x32_bf16 v[224:227], a[164:167], a[196:199], v[224:227]
    v_mfma_f32_16x16x32_bf16 v[224:227], a[168:171], a[200:203], v[224:227]
    s_waitcnt vmcnt(13)
    v_fma_f32 v216, v124, v216, v124
    v_fma_f32 v217, v125, v217, v125
    v_mfma_f32_16x16x32_bf16 v[224:227], a[172:175], a[204:207], v[224:227]
    s_waitcnt vmcnt(12)
    v_cvt_pk_bf16_f32 v190, v216, v217
    v_fma_f32 v218, v126, v218, v126
    v_mfma_f32_16x16x32_bf16 v[200:203], a[176:179], a[192:195], v[200:203]
    s_waitcnt vmcnt(11)
    global_load_dwordx4 a[36:39], v250, s[38:39] offset:-3968 sc1
    v_fma_f32 v219, v127, v219, v127
    v_mfma_f32_16x16x32_bf16 v[200:203], a[180:183], a[196:199], v[200:203]
    v_cvt_pk_bf16_f32 v191, v218, v219
    s_waitcnt vmcnt(11) lgkmcnt(0)
    ds_write_b128 v245, v[188:191] offset:15872
    v_cvt_pk_bf16_f32 v224, v224, v225
    v_cvt_pk_bf16_f32 v225, v226, v227
    v_mfma_f32_16x16x32_bf16 v[200:203], a[184:187], a[200:203], v[200:203]
    global_load_dwordx4 a[40:43], v250, s[38:39] offset:-3840 sc1
    s_waitcnt vmcnt(11)
    v_mfma_f32_16x16x32_bf16 v[200:203], a[188:191], a[204:207], v[200:203]
    v_mfma_f32_16x16x32_bf16 v[204:207], a[160:163], a[224:227], v[204:207]
    global_load_dwordx4 a[44:47], v250, s[38:39] offset:-3712 sc1
    v_mfma_f32_16x16x32_bf16 v[204:207], a[164:167], a[228:231], v[204:207]
    s_waitcnt lgkmcnt(0)
    s_barrier
    ds_read_b128 a[240:243], v246 offset:8704
    v_mfma_f32_16x16x32_bf16 v[204:207], a[168:171], a[232:235], v[204:207]
    v_cvt_pk_bf16_f32 v226, v200, v201
    v_cvt_pk_bf16_f32 v227, v202, v203
    v_mfma_f32_16x16x32_bf16 v[204:207], a[172:175], a[236:239], v[204:207]
    ds_write_b128 v245, v[224:227] offset:17408
    v_mfma_f32_16x16x32_bf16 v[212:215], a[176:179], a[224:227], v[212:215]
    global_load_dwordx4 a[48:51], v250, s[38:39] offset:0 sc1
    v_mfma_f32_16x16x32_bf16 v[212:215], a[180:183], a[228:231], v[212:215]
    v_mfma_f32_16x16x32_bf16 v[212:215], a[184:187], a[232:235], v[212:215]
    v_cvt_pk_bf16_f32 v204, v204, v205
    v_cvt_pk_bf16_f32 v205, v206, v207
    v_mfma_f32_16x16x32_bf16 v[212:215], a[188:191], a[236:239], v[212:215]
    ds_read_b128 a[208:211], v245 offset:17408
    ds_read_b128 a[244:247], v246 offset:9728
    v_mfma_f32_16x16x32_bf16 v[228:231], a[64:67], v[160:163], 0
    global_load_dwordx4 a[52:55], v250, s[38:39] offset:128 sc1
    ds_read_b128 a[248:251], v246 offset:10752
    v_mfma_f32_16x16x32_bf16 v[228:231], a[68:71], v[164:167], v[228:231]
    ds_read_b128 a[252:255], v246 offset:11776
    ds_read_b128 a[224:227], v246 offset:12800
    v_mfma_f32_16x16x32_bf16 v[228:231], a[72:75], v[168:171], v[228:231]
    v_cvt_pk_bf16_f32 v206, v212, v213
    v_cvt_pk_bf16_f32 v207, v214, v215
    v_mfma_f32_16x16x32_bf16 v[228:231], a[76:79], v[172:175], v[228:231]
    ds_write_b128 v245, v[204:207] offset:18432
    v_mfma_f32_16x16x32_bf16 v[192:195], a[80:83], v[160:163], 0
    global_load_dwordx4 a[56:59], v250, s[38:39] offset:256 sc1
    v_mfma_f32_16x16x32_bf16 v[192:195], a[84:87], v[164:167], v[192:195]
    v_mfma_f32_16x16x32_bf16 v[192:195], a[88:91], v[168:171], v[192:195]
    ds_read_b128 a[192:195], v245 offset:18432
    ds_read_b128 a[228:231], v246 offset:13824
    v_mfma_f32_16x16x32_bf16 v[192:195], a[92:95], v[172:175], v[192:195]
    ds_read_b128 a[232:235], v246 offset:14848
    ds_read_b128 a[236:239], v246 offset:15872
    v_mfma_f32_16x16x32_bf16 v[196:199], a[64:67], v[176:179], 0
    global_load_dwordx4 a[60:63], v250, s[38:39] offset:384 sc1
    v_mfma_f32_16x16x32_bf16 v[196:199], a[68:71], v[180:183], v[196:199]
    s_waitcnt vmcnt(13) lgkmcnt(4)
    s_barrier
    ds_read_b128 a[212:215], v246 offset:17408
    v_mfma_f32_16x16x32_bf16 v[196:199], a[72:75], v[184:187], v[196:199]
    ds_read_b128 a[216:219], v247 offset:17408
    ds_read_b128 a[220:223], v248 offset:17408
    v_mfma_f32_16x16x32_bf16 v[196:199], a[76:79], v[188:191], v[196:199]
    ds_read_b128 a[196:199], v246 offset:18432
    ds_read_b128 a[200:203], v247 offset:18432
    v_mfma_f32_16x16x32_bf16 v[208:211], a[80:83], v[176:179], 0
    global_load_dwordx4 a[64:67], v250, s[40:41] offset:-4096 sc1
    ds_read_b128 a[204:207], v248 offset:18432
    v_mfma_f32_16x16x32_bf16 v[208:211], a[84:87], v[180:183], v[208:211]
    v_mfma_f32_16x16x32_bf16 v[208:211], a[88:91], v[184:187], v[208:211]
    v_mfma_f32_16x16x32_bf16 v[208:211], a[92:95], v[188:191], v[208:211]
    v_mfma_f32_16x16x32_bf16 v[220:223], a[0:3], a[208:211], v[236:239]
    global_load_dwordx4 a[68:71], v250, s[40:41] offset:-3968 sc1
    s_waitcnt vmcnt(13) lgkmcnt(5)
    v_mfma_f32_16x16x32_bf16 v[220:223], a[4:7], a[212:215], v[220:223]
    s_waitcnt lgkmcnt(3)
    v_mfma_f32_16x16x32_bf16 v[220:223], a[8:11], a[216:219], v[220:223]
    v_mfma_f32_16x16x32_bf16 v[220:223], a[12:15], a[220:223], v[220:223]
    global_load_dwordx4 a[72:75], v250, s[40:41] offset:-3840 sc1
    v_mfma_f32_16x16x32_bf16 v[228:231], a[96:99], a[240:243], v[228:231]
    v_mfma_f32_16x16x32_bf16 v[228:231], a[100:103], a[244:247], v[228:231]
    v_mfma_f32_16x16x32_bf16 v[228:231], a[104:107], a[248:251], v[228:231]
    s_nop 0
    v_fmac_f32 v240, v0, v220
    v_fmac_f32 v241, v1, v221
    v_mfma_f32_16x16x32_bf16 v[228:231], a[108:111], a[252:255], v[228:231]
    global_load_dwordx4 a[76:79], v250, s[40:41] offset:-3712 sc1
    v_cvt_pk_bf16_f32 v128, v240, v241
    v_mfma_f32_16x16x32_bf16 v[216:219], a[0:3], a[192:195], v[236:239]
    s_waitcnt vmcnt(13) lgkmcnt(0)
    v_fmac_f32 v242, v2, v222
    v_fmac_f32 v243, v3, v223
    v_mfma_f32_16x16x32_bf16 v[216:219], a[4:7], a[196:199], v[216:219]
    v_cvt_pk_bf16_f32 v129, v242, v243
    v_lshlrev_b32 v240, 16, v144
    v_mfma_f32_16x16x32_bf16 v[216:219], a[8:11], a[200:203], v[216:219]
    v_and_b32 v241, s84, v144
    v_lshlrev_b32 v242, 16, v145
    v_mfma_f32_16x16x32_bf16 v[216:219], a[12:15], a[204:207], v[216:219]
    global_load_dwordx4 a[80:83], v250, s[40:41] offset:0 sc1
    v_and_b32 v243, s84, v145
    v_mfma_f32_16x16x32_bf16 v[192:195], a[112:115], a[240:243], v[192:195]
    ds_read_b128 a[240:243], v247 offset:8704
    ds_read_b128 v[236:239], v251 offset:656
    v_mfma_f32_16x16x32_bf16 v[192:195], a[116:119], a[244:247], v[192:195]
    ds_read_b128 a[244:247], v247 offset:9728
    v_mfma_f32_16x16x32_bf16 v[192:195], a[120:123], a[248:251], v[192:195]
    v_fmac_f32 v240, v32, v216
    v_fmac_f32 v241, v33, v217
    v_mfma_f32_16x16x32_bf16 v[192:195], a[124:127], a[252:255], v[192:195]
    global_load_dwordx4 a[84:87], v250, s[40:41] offset:128 sc1
    v_cvt_pk_bf16_f32 v144, v240, v241
    v_mfma_f32_16x16x32_bf16 v[200:203], a[16:19], a[208:211], v[232:235]
    v_fmac_f32 v242, v34, v218
    v_fmac_f32 v243, v35, v219
    v_mfma_f32_16x16x32_bf16 v[200:203], a[20:23], a[212:215], v[200:203]
    v_cvt_pk_bf16_f32 v145, v242, v243
    v_lshlrev_b32 v240, 16, v130
    v_mfma_f32_16x16x32_bf16 v[200:203], a[24:27], a[216:219], v[200:203]
    s_waitcnt vmcnt(13)
    v_and_b32 v241, s84, v130
    v_lshlrev_b32 v242, 16, v131
    v_mfma_f32_16x16x32_bf16 v[200:203], a[28:31], a[220:223], v[200:203]
    global_load_dwordx4 a[88:91], v250, s[40:41] offset:256 sc1
    v_and_b32 v243, s84, v131
    v_mfma_f32_16x16x32_bf16 v[196:199], a[96:99], a[224:227], v[196:199]
    ds_read_b128 a[248:251], v247 offset:10752
    ds_read_b128 a[252:255], v247 offset:11776
    v_mfma_f32_16x16x32_bf16 v[196:199], a[100:103], a[228:231], v[196:199]
    v_mfma_f32_16x16x32_bf16 v[196:199], a[104:107], a[232:235], v[196:199]
    v_fmac_f32 v240, v4, v200
    v_fmac_f32 v241, v5, v201
    v_mfma_f32_16x16x32_bf16 v[196:199], a[108:111], a[236:239], v[196:199]
    global_load_dwordx4 a[92:95], v250, s[40:41] offset:384 sc1
    v_cvt_pk_bf16_f32 v130, v240, v241
    v_mfma_f32_16x16x32_bf16 v[224:227], a[16:19], a[192:195], v[232:235]
    v_fmac_f32 v242, v6, v202
    v_fmac_f32 v243, v7, v203
    v_mfma_f32_16x16x32_bf16 v[224:227], a[20:23], a[196:199], v[224:227]
    v_cvt_pk_bf16_f32 v131, v242, v243
    v_lshlrev_b32 v240, 16, v146
    v_mfma_f32_16x16x32_bf16 v[224:227], a[24:27], a[200:203], v[224:227]
    v_and_b32 v241, s84, v146
    v_lshlrev_b32 v242, 16, v147
    v_mfma_f32_16x16x32_bf16 v[224:227], a[28:31], a[204:207], v[224:227]
    global_load_dwordx4 a[96:99], v250, s[42:43] offset:-4096 sc1
    v_and_b32 v243, s84, v147
    v_mfma_f32_16x16x32_bf16 v[208:211], a[112:115], a[224:227], v[208:211]
    ds_write_b128 v245, v[128:131] offset:0
    v_mfma_f32_16x16x32_bf16 v[208:211], a[116:119], a[228:231], v[208:211]
    v_mfma_f32_16x16x32_bf16 v[208:211], a[120:123], a[232:235], v[208:211]
    v_fmac_f32 v240, v36, v224
    v_fmac_f32 v241, v37, v225
    v_mfma_f32_16x16x32_bf16 v[208:211], a[124:127], a[236:239], v[208:211]
    global_load_dwordx4 a[100:103], v250, s[42:43] offset:-3968 sc1
    v_cvt_pk_bf16_f32 v146, v240, v241
    v_mfma_f32_16x16x32_bf16 v[212:215], a[32:35], a[208:211], v[252:255]
    s_waitcnt vmcnt(13) lgkmcnt(1)
    v_fmac_f32 v242, v38, v226
    v_fmac_f32 v243, v39, v227
    v_mfma_f32_16x16x32_bf16 v[212:215], a[36:39], a[212:215], v[212:215]
    ds_read_b128 v[232:235], v251 offset:768
    v_cvt_pk_bf16_f32 v147, v242, v243
    v_mfma_f32_16x16x32_bf16 v[212:215], a[40:43], a[216:219], v[212:215]
    ds_write_b128 v245, v[144:147] offset:4096
    v_mfma_f32_16x16x32_bf16 v[212:215], a[44:47], a[220:223], v[212:215]
    global_load_dwordx4 a[104:107], v250, s[42:43] offset:-3840 sc1
    v_lshlrev_b32 v240, 16, v132
    v_mfma_f32_16x16x32_bf16 v[228:231], a[128:131], a[240:243], v[228:231]
    v_and_b32 v241, s84, v132
    v_lshlrev_b32 v242, 16, v133
    v_mfma_f32_16x16x32_bf16 v[228:231], a[132:135], a[244:247], v[228:231]
    ds_read_b128 a[224:227], v247 offset:12800
    ds_read_b128 a[228:231], v247 offset:13824
    v_mfma_f32_16x16x32_bf16 v[228:231], a[136:139], a[248:251], v[228:231]
    ds_read_b128 a[232:235], v247 offset:14848
    ds_read_b128 a[236:239], v247 offset:15872
    v_mfma_f32_16x16x32_bf16 v[228:231], a[140:143], a[252:255], v[228:231]
    global_load_dwordx4 a[108:111], v250, s[42:43] offset:-3712 sc1
    v_and_b32 v243, s84, v133
    v_mfma_f32_16x16x32_bf16 v[204:207], a[32:35], a[192:195], v[252:255]
    v_fmac_f32 v240, v8, v212
    v_fmac_f32 v241, v9, v213
    v_mfma_f32_16x16x32_bf16 v[204:207], a[36:39], a[196:199], v[204:207]
    v_cvt_pk_bf16_f32 v132, v240, v241
    v_fmac_f32 v242, v10, v214
    v_mfma_f32_16x16x32_bf16 v[204:207], a[40:43], a[200:203], v[204:207]
    v_fmac_f32 v243, v11, v215
    v_cvt_pk_bf16_f32 v133, v242, v243
    v_mfma_f32_16x16x32_bf16 v[204:207], a[44:47], a[204:207], v[204:207]
    global_load_dwordx4 a[112:115], v250, s[42:43] offset:0 sc1
    v_lshlrev_b32 v240, 16, v148
    v_mfma_f32_16x16x32_bf16 v[192:195], a[144:147], a[240:243], v[192:195]
    v_and_b32 v241, s84, v148
    v_lshlrev_b32 v242, 16, v149
    v_mfma_f32_16x16x32_bf16 v[192:195], a[148:151], a[244:247], v[192:195]
    ds_read_b128 a[240:243], v248 offset:8704
    v_and_b32 v243, s84, v149
    v_mfma_f32_16x16x32_bf16 v[192:195], a[152:155], a[248:251], v[192:195]
    ds_read_b128 a[244:247], v248 offset:9728
    v_fmac_f32 v240, v40, v204
    v_mfma_f32_16x16x32_bf16 v[192:195], a[156:159], a[252:255], v[192:195]
    global_load_dwordx4 a[116:119], v250, s[42:43] offset:128 sc1
    v_fmac_f32 v241, v41, v205
    v_mfma_f32_16x16x32_bf16 v[220:223], a[48:51], a[208:211], v[236:239]
    s_waitcnt vmcnt(13) lgkmcnt(2)
    v_cvt_pk_bf16_f32 v148, v240, v241
    v_fmac_f32 v242, v42, v206
    v_mfma_f32_16x16x32_bf16 v[220:223], a[52:55], a[212:215], v[220:223]
    v_fmac_f32 v243, v43, v207
    v_cvt_pk_bf16_f32 v149, v242, v243
    v_mfma_f32_16x16x32_bf16 v[220:223], a[56:59], a[216:219], v[220:223]
    v_lshlrev_b32 v240, 16, v134
    v_and_b32 v241, s84, v134
    v_mfma_f32_16x16x32_bf16 v[220:223], a[60:63], a[220:223], v[220:223]
    global_load_dwordx4 a[120:123], v250, s[42:43] offset:256 sc1
    v_lshlrev_b32 v242, 16, v135
    v_mfma_f32_16x16x32_bf16 v[196:199], a[128:131], a[224:227], v[196:199]
    ds_read_b128 a[248:251], v248 offset:10752
    v_and_b32 v243, s84, v135
    v_mfma_f32_16x16x32_bf16 v[196:199], a[132:135], a[228:231], v[196:199]
    ds_read_b128 a[252:255], v248 offset:11776
    ds_read_b128 v[252:255], v251 offset:784
    v_mfma_f32_16x16x32_bf16 v[196:199], a[136:139], a[232:235], v[196:199]
    v_fmac_f32 v240, v12, v220
    v_fmac_f32 v241, v13, v221
    v_mfma_f32_16x16x32_bf16 v[196:199], a[140:143], a[236:239], v[196:199]
    global_load_dwordx4 a[124:127], v250, s[42:43] offset:384 sc1
    v_cvt_pk_bf16_f32 v134, v240, v241
    v_mfma_f32_16x16x32_bf16 v[216:219], a[48:51], a[192:195], v[236:239]
    v_add_u32 v250, 0x20000, v250
    v_fmac_f32 v242, v14, v222
    v_mfma_f32_16x16x32_bf16 v[216:219], a[52:55], a[196:199], v[216:219]
    v_fmac_f32 v243, v15, v223
    v_cvt_pk_bf16_f32 v135, v242, v243
    v_mfma_f32_16x16x32_bf16 v[216:219], a[56:59], a[200:203], v[216:219]
    v_lshlrev_b32 v240, 16, v150
    v_and_b32 v241, s84, v150
    v_mfma_f32_16x16x32_bf16 v[216:219], a[60:63], a[204:207], v[216:219]
    global_load_dwordx4 a[128:131], v250, s[36:37] offset:-4096 sc1
    v_lshlrev_b32 v242, 16, v151
    v_mfma_f32_16x16x32_bf16 v[208:211], a[144:147], a[224:227], v[208:211]
    ds_write_b128 v245, v[132:135] offset:1024
    v_mfma_f32_16x16x32_bf16 v[208:211], a[148:151], a[228:231], v[208:211]
    v_and_b32 v243, s84, v151
    v_mfma_f32_16x16x32_bf16 v[208:211], a[152:155], a[232:235], v[208:211]
    v_fmac_f32 v240, v44, v216
    v_fmac_f32 v241, v45, v217
    v_mfma_f32_16x16x32_bf16 v[208:211], a[156:159], a[236:239], v[208:211]
    global_load_dwordx4 a[132:135], v250, s[36:37] offset:-3968 sc1
    v_cvt_pk_bf16_f32 v150, v240, v241
    v_mfma_f32_16x16x32_bf16 v[200:203], a[64:67], a[208:211], v[232:235]
    s_waitcnt vmcnt(13) lgkmcnt(1)
    v_fmac_f32 v242, v46, v218
    v_fmac_f32 v243, v47, v219
    v_mfma_f32_16x16x32_bf16 v[200:203], a[68:71], a[212:215], v[200:203]
    ds_read_b128 v[236:239], v251 offset:896
    v_cvt_pk_bf16_f32 v151, v242, v243
    v_mfma_f32_16x16x32_bf16 v[200:203], a[72:75], a[216:219], v[200:203]
    ds_write_b128 v245, v[148:151] offset:5120
    v_mfma_f32_16x16x32_bf16 v[200:203], a[76:79], a[220:223], v[200:203]
    global_load_dwordx4 a[136:139], v250, s[36:37] offset:-3840 sc1
    v_lshlrev_b32 v240, 16, v136
    v_mfma_f32_16x16x32_bf16 v[228:231], a[160:163], a[240:243], v[228:231]
    v_and_b32 v241, s84, v136
    v_lshlrev_b32 v242, 16, v137
    v_mfma_f32_16x16x32_bf16 v[228:231], a[164:167], a[244:247], v[228:231]
    ds_read_b128 a[224:227], v248 offset:12800
    ds_read_b128 a[228:231], v248 offset:13824
    v_mfma_f32_16x16x32_bf16 v[228:231], a[168:171], a[248:251], v[228:231]
    ds_read_b128 a[232:235], v248 offset:14848
    v_and_b32 v243, s84, v137
    v_mfma_f32_16x16x32_bf16 v[228:231], a[172:175], a[252:255], v[228:231]
    global_load_dwordx4 a[140:143], v250, s[36:37] offset:-3712 sc1
    ds_read_b128 a[236:239], v248 offset:15872
    v_mfma_f32_16x16x32_bf16 v[224:227], a[64:67], a[192:195], v[232:235]
    v_fmac_f32 v240, v16, v200
    v_fmac_f32 v241, v17, v201
    v_mfma_f32_16x16x32_bf16 v[224:227], a[68:71], a[196:199], v[224:227]
    v_cvt_pk_bf16_f32 v136, v240, v241
    v_fmac_f32 v242, v18, v202
    v_mfma_f32_16x16x32_bf16 v[224:227], a[72:75], a[200:203], v[224:227]
    v_fmac_f32 v243, v19, v203
    v_cvt_pk_bf16_f32 v137, v242, v243
    v_mfma_f32_16x16x32_bf16 v[224:227], a[76:79], a[204:207], v[224:227]
    global_load_dwordx4 a[144:147], v250, s[36:37] offset:0 sc1
    v_lshlrev_b32 v240, 16, v152
    v_mfma_f32_16x16x32_bf16 v[192:195], a[176:179], a[240:243], v[192:195]
    v_and_b32 v241, s84, v152
    v_lshlrev_b32 v242, 16, v153
    v_mfma_f32_16x16x32_bf16 v[192:195], a[180:183], a[244:247], v[192:195]
    v_and_b32 v243, s84, v153
    v_cvt_pk_bf16_f32 v228, v228, v229
    v_mfma_f32_16x16x32_bf16 v[192:195], a[184:187], a[248:251], v[192:195]
    v_fmac_f32 v240, v48, v224
    v_cvt_pk_bf16_f32 v229, v230, v231
    v_mfma_f32_16x16x32_bf16 v[192:195], a[188:191], a[252:255], v[192:195]
    global_load_dwordx4 a[148:151], v250, s[36:37] offset:128 sc1
    v_fmac_f32 v241, v49, v225
    v_mfma_f32_16x16x32_bf16 v[212:215], a[80:83], a[208:211], v[252:255]
    s_waitcnt vmcnt(13) lgkmcnt(0)
    v_cvt_pk_bf16_f32 v152, v240, v241
    v_fmac_f32 v242, v50, v226
    v_mfma_f32_16x16x32_bf16 v[212:215], a[84:87], a[212:215], v[212:215]
    v_fmac_f32 v243, v51, v227
    v_cvt_pk_bf16_f32 v153, v242, v243
    v_mfma_f32_16x16x32_bf16 v[212:215], a[88:91], a[216:219], v[212:215]
    v_lshlrev_b32 v240, 16, v138
    v_cvt_pk_bf16_f32 v230, v192, v193
    v_mfma_f32_16x16x32_bf16 v[212:215], a[92:95], a[220:223], v[212:215]
    global_load_dwordx4 a[152:155], v250, s[36:37] offset:256 sc1
    v_and_b32 v241, s84, v138
    v_mfma_f32_16x16x32_bf16 v[196:199], a[160:163], a[224:227], v[196:199]
    v_lshlrev_b32 v242, 16, v139
    v_cvt_pk_bf16_f32 v231, v194, v195
    v_mfma_f32_16x16x32_bf16 v[196:199], a[164:167], a[228:231], v[196:199]
    ds_write_b128 v245, v[228:231] offset:19456
    v_mfma_f32_16x16x32_bf16 v[196:199], a[168:171], a[232:235], v[196:199]
    v_fmac_f32 v240, v20, v212
    v_fmac_f32 v241, v21, v213
    v_mfma_f32_16x16x32_bf16 v[196:199], a[172:175], a[236:239], v[196:199]
    global_load_dwordx4 a[156:159], v250, s[36:37] offset:384 sc1
    v_and_b32 v243, s84, v139
    v_mfma_f32_16x16x32_bf16 v[204:207], a[80:83], a[192:195], v[252:255]
L_st2:
    s_cbranch_execz L_wret
    v_cvt_pk_bf16_f32 v138, v240, v241
    v_fmac_f32 v242, v22, v214
    v_mfma_f32_16x16x32_bf16 v[204:207], a[84:87], a[196:199], v[204:207]
    v_fmac_f32 v243, v23, v215
    v_cvt_pk_bf16_f32 v139, v242, v243
    v_mfma_f32_16x16x32_bf16 v[204:207], a[88:91], a[200:203], v[204:207]
    ds_write_b128 v245, v[136:139] offset:2048
    v_mfma_f32_16x16x32_bf16 v[204:207], a[92:95], a[204:207], v[204:207]
    global_load_dwordx4 a[160:163], v250, s[38:39] offset:-4096 sc1
    v_cvt_pk_bf16_f32 v196, v196, v197
    v_mfma_f32_16x16x32_bf16 v[208:211], a[176:179], a[224:227], v[208:211]
    v_cvt_pk_bf16_f32 v197, v198, v199
    v_lshlrev_b32 v240, 16, v154
    v_mfma_f32_16x16x32_bf16 v[208:211], a[180:183], a[228:231], v[208:211]
    ds_read_b128 v[232:235], v251 offset:912
    ds_read_b128 a[240:243], v245 offset:19456
    v_mfma_f32_16x16x32_bf16 v[208:211], a[184:187], a[232:235], v[208:211]
    ds_read_b128 v[252:255], v251 offset:512
    v_and_b32 v241, s84, v154
    v_mfma_f32_16x16x32_bf16 v[208:211], a[188:191], a[236:239], v[208:211]
    global_load_dwordx4 a[164:167], v250, s[38:39] offset:-3968 sc1
    v_lshlrev_b32 v242, 16, v155
    v_mfma_f32_16x16x32_bf16 v[220:223], a[96:99], a[208:211], v[236:239]
    s_waitcnt vmcnt(13) lgkmcnt(4)
    v_fmac_f32 v240, v52, v204
    v_and_b32 v243, s84, v155
    v_mfma_f32_16x16x32_bf16 v[220:223], a[100:103], a[212:215], v[220:223]
    v_fmac_f32 v241, v53, v205
    v_cvt_pk_bf16_f32 v154, v240, v241
    v_mfma_f32_16x16x32_bf16 v[220:223], a[104:107], a[216:219], v[220:223]
    v_cvt_pk_bf16_f32 v198, v208, v209
    v_cvt_pk_bf16_f32 v199, v210, v211
    v_mfma_f32_16x16x32_bf16 v[220:223], a[108:111], a[220:223], v[220:223]
    ds_write_b128 v245, v[196:199] offset:20480
    v_mfma_f32_16x16x32_bf16 v[216:219], a[96:99], a[192:195], v[236:239]
    global_load_dwordx4 a[168:171], v250, s[38:39] offset:-3840 sc1
    v_fmac_f32 v242, v54, v206
    v_mfma_f32_16x16x32_bf16 v[216:219], a[100:103], a[196:199], v[216:219]
    v_fmac_f32 v243, v55, v207
    v_cvt_pk_bf16_f32 v155, v242, v243
    v_mfma_f32_16x16x32_bf16 v[216:219], a[104:107], a[200:203], v[216:219]
    ds_read_b128 a[224:227], v245 offset:20480
    ds_read_b128 v[236:239], v251 offset:528
    v_mfma_f32_16x16x32_bf16 v[216:219], a[108:111], a[204:207], v[216:219]
    s_waitcnt vmcnt(12) lgkmcnt(3)
    v_lshlrev_b32 v240, 16, v140
    v_and_b32 v241, s84, v140
    v_mfma_f32_16x16x32_bf16 v[200:203], a[112:115], a[208:211], v[232:235]
    global_load_dwordx4 a[172:175], v250, s[38:39] offset:-3712 sc1
    v_fmac_f32 v240, v24, v220
    v_mfma_f32_16x16x32_bf16 v[200:203], a[116:119], a[212:215], v[200:203]
    s_waitcnt lgkmcnt(2)
    s_barrier
    ds_read_b128 a[244:247], v246 offset:19456
    v_mfma_f32_16x16x32_bf16 v[200:203], a[120:123], a[216:219], v[200:203]
    s_waitcnt vmcnt(12)
    ds_read_b128 a[248:251], v247 offset:19456
    ds_read_b128 a[252:255], v248 offset:19456
    v_mfma_f32_16x16x32_bf16 v[200:203], a[124:127], a[220:223], v[200:203]
    ds_read_b128 a[228:231], v246 offset:20480
    ds_read_b128 a[232:235], v247 offset:20480
    v_mfma_f32_16x16x32_bf16 v[224:227], a[112:115], a[192:195], v[232:235]
    global_load_dwordx4 a[176:179], v250, s[38:39] offset:0 sc1
    ds_read_b128 a[236:239], v248 offset:20480
    v_mfma_f32_16x16x32_bf16 v[224:227], a[116:119], a[196:199], v[224:227]
    v_lshlrev_b32 v242, 16, v141
    v_and_b32 v243, s84, v141
    v_mfma_f32_16x16x32_bf16 v[224:227], a[120:123], a[200:203], v[224:227]
    v_fmac_f32 v241, v25, v221
    v_cvt_pk_bf16_f32 v140, v240, v241
    v_mfma_f32_16x16x32_bf16 v[224:227], a[124:127], a[204:207], v[224:227]
    v_fmac_f32 v242, v26, v222
    v_fmac_f32 v243, v27, v223
    v_mfma_f32_16x16x32_bf16 v[192:195], a[0:3], a[240:243], v[252:255]
    global_load_dwordx4 a[180:183], v250, s[38:39] offset:128 sc1
    v_cvt_pk_bf16_f32 v141, v242, v243
    s_waitcnt vmcnt(13) lgkmcnt(5)
    v_lshlrev_b32 v240, 16, v156
    v_and_b32 v241, s84, v156
    v_lshlrev_b32 v242, 16, v157
    v_fmac_f32 v240, v56, v216
    v_mfma_f32_16x16x32_bf16 v[192:195], a[4:7], a[244:247], v[192:195]
    s_waitcnt lgkmcnt(3)
    v_fmac_f32 v241, v57, v217
    v_and_b32 v243, s84, v157
    v_mfma_f32_16x16x32_bf16 v[192:195], a[8:11], a[248:251], v[192:195]
    v_cvt_pk_bf16_f32 v156, v240, v241
    v_fmac_f32 v242, v58, v218
    v_mfma_f32_16x16x32_bf16 v[192:195], a[12:15], a[252:255], v[192:195]
    global_load_dwordx4 a[184:187], v250, s[38:39] offset:256 sc1
    v_fmac_f32 v243, v59, v219
    v_mfma_f32_16x16x32_bf16 v[228:231], a[0:3], a[224:227], v[252:255]
    s_waitcnt vmcnt(13) lgkmcnt(0)
    v_cvt_pk_bf16_f32 v157, v242, v243
    v_lshlrev_b32 v240, 16, v142
    v_mfma_f32_16x16x32_bf16 v[228:231], a[4:7], a[228:231], v[228:231]
    ds_read_b128 v[232:235], v251 offset:640
    v_and_b32 v241, s84, v142
    v_mfma_f32_16x16x32_bf16 v[228:231], a[8:11], a[232:235], v[228:231]
    v_lshlrev_b32 v242, 16, v143
    v_fmac_f32 v240, v28, v200
    v_mfma_f32_16x16x32_bf16 v[228:231], a[12:15], a[236:239], v[228:231]
    global_load_dwordx4 a[188:191], v250, s[38:39] offset:384 sc1
    v_fmac_f32 v241, v29, v201
    v_mfma_f32_16x16x32_bf16 v[212:215], a[16:19], a[240:243], v[236:239]
    v_and_b32 v243, s84, v143
    v_cvt_pk_bf16_f32 v142, v240, v241
    v_mfma_f32_16x16x32_bf16 v[212:215], a[20:23], a[244:247], v[212:215]
    v_fmac_f32 v242, v30, v202
    v_fmac_f32 v243, v31, v203
    v_mfma_f32_16x16x32_bf16 v[212:215], a[24:27], a[248:251], v[212:215]
    v_cvt_pk_bf16_f32 v143, v242, v243
    v_lshlrev_b32 v240, 16, v158
    v_mfma_f32_16x16x32_bf16 v[212:215], a[28:31], a[252:255], v[212:215]
    global_load_dwordx4 a[0:3], v250, s[40:41] offset:-4096 sc1
    v_and_b32 v241, s84, v158
    v_mfma_f32_16x16x32_bf16 v[204:207], a[16:19], a[224:227], v[236:239]
    ds_write_b128 v245, v[152:155] offset:6144
    v_mfma_f32_16x16x32_bf16 v[204:207], a[20:23], a[228:231], v[204:207]
    v_lshlrev_b32 v242, 16, v159
    v_fmac_f32 v240, v60, v224
    v_mfma_f32_16x16x32_bf16 v[204:207], a[24:27], a[232:235], v[204:207]
    ds_write_b128 v245, v[140:143] offset:3072
    v_mfma_f32_16x16x32_bf16 v[204:207], a[28:31], a[236:239], v[204:207]
    global_load_dwordx4 a[4:7], v250, s[40:41] offset:-3968 sc1
    v_fmac_f32 v241, v61, v225
    v_mfma_f32_16x16x32_bf16 v[208:211], a[128:131], v[128:131], 0
    v_and_b32 v243, s84, v159
    v_cvt_pk_bf16_f32 v158, v240, v241
    v_mfma_f32_16x16x32_bf16 v[208:211], a[132:135], v[132:135], v[208:211]
    s_waitcnt vmcnt(13) lgkmcnt(2)
    v_fmac_f32 v242, v62, v226
    v_fmac_f32 v243, v63, v227
    v_mfma_f32_16x16x32_bf16 v[208:211], a[136:139], v[136:139], v[208:211]
    v_cvt_pk_bf16_f32 v159, v242, v243
    v_lshlrev_b32 v240, 16, v160
    v_mfma_f32_16x16x32_bf16 v[208:211], a[140:143], v[140:143], v[208:211]
    global_load_dwordx4 a[8:11], v250, s[40:41] offset:-3840 sc1
    ds_read_b128 v[252:255], v251 offset:656
    v_mfma_f32_16x16x32_bf16 v[196:199], a[32:35], a[240:243], v[232:235]
    ds_write_b128 v245, v[156:159] offset:7168
    v_mfma_f32_16x16x32_bf16 v[196:199], a[36:39], a[244:247], v[196:199]
    v_and_b32 v241, s84, v160
    v_lshlrev_b32 v242, 16, v161
    v_mfma_f32_16x16x32_bf16 v[196:199], a[40:43], a[248:251], v[196:199]
    v_fmac_f32 v240, v64, v192
    v_and_b32 v243, s84, v161
    v_mfma_f32_16x16x32_bf16 v[196:199], a[44:47], a[252:255], v[196:199]
    global_load_dwordx4 a[12:15], v250, s[40:41] offset:-3712 sc1
    v_fmac_f32 v241, v65, v193
    v_mfma_f32_16x16x32_bf16 v[220:223], a[144:147], v[128:131], 0
    s_waitcnt vmcnt(13) lgkmcnt(2)
    v_cvt_pk_bf16_f32 v160, v240, v241
    v_fmac_f32 v242, v66, v194
    v_mfma_f32_16x16x32_bf16 v[220:223], a[148:151], v[132:135], v[220:223]
    v_fmac_f32 v243, v67, v195
    v_cvt_pk_bf16_f32 v161, v242, v243
    v_mfma_f32_16x16x32_bf16 v[220:223], a[152:155], v[136:139], v[220:223]
    s_waitcnt vmcnt(12) lgkmcnt(0)
    s_barrier
    ds_read_b128 a[208:211], v246 offset:0
    v_mfma_f32_16x16x32_bf16 v[220:223], a[156:159], v[140:143], v[220:223]
    global_load_dwordx4 a[16:19], v250, s[40:41] offset:0 sc1
    ds_read_b128 a[212:215], v246 offset:1024
    v_mfma_f32_16x16x32_bf16 v[216:219], a[32:35], a[224:227], v[232:235]
    ds_read_b128 a[216:219], v246 offset:2048
    ds_read_b128 a[220:223], v246 offset:3072
    v_mfma_f32_16x16x32_bf16 v[216:219], a[36:39], a[228:231], v[216:219]
    ds_read_b128 a[192:195], v246 offset:4096
    v_lshlrev_b32 v240, 16, v176
    v_mfma_f32_16x16x32_bf16 v[216:219], a[40:43], a[232:235], v[216:219]
    ds_read_b128 a[196:199], v246 offset:5120
    v_and_b32 v241, s84, v176
    v_mfma_f32_16x16x32_bf16 v[216:219], a[44:47], a[236:239], v[216:219]
    global_load_dwordx4 a[20:23], v250, s[40:41] offset:128 sc1
    v_lshlrev_b32 v242, 16, v177
    v_mfma_f32_16x16x32_bf16 v[200:203], a[128:131], v[144:147], 0
    ds_read_b128 a[200:203], v246 offset:6144
    v_and_b32 v243, s84, v177
    v_mfma_f32_16x16x32_bf16 v[200:203], a[132:135], v[148:151], v[200:203]
    ds_read_b128 a[204:207], v246 offset:7168
    v_fmac_f32 v240, v96, v228
    v_mfma_f32_16x16x32_bf16 v[200:203], a[136:139], v[152:155], v[200:203]
    v_fmac_f32 v241, v97, v229
    v_cvt_pk_bf16_f32 v176, v240, v241
    v_mfma_f32_16x16x32_bf16 v[200:203], a[140:143], v[156:159], v[200:203]
    global_load_dwordx4 a[24:27], v250, s[40:41] offset:256 sc1
    v_fmac_f32 v242, v98, v230
    v_mfma_f32_16x16x32_bf16 v[224:227], a[48:51], a[240:243], v[252:255]
    v_fmac_f32 v243, v99, v231
    v_cvt_pk_bf16_f32 v177, v242, v243
    v_mfma_f32_16x16x32_bf16 v[224:227], a[52:55], a[244:247], v[224:227]
    v_lshlrev_b32 v240, 16, v162
    v_and_b32 v241, s84, v162
    v_mfma_f32_16x16x32_bf16 v[224:227], a[56:59], a[248:251], v[224:227]
    v_lshlrev_b32 v242, 16, v163
    v_and_b32 v243, s84, v163
    v_mfma_f32_16x16x32_bf16 v[224:227], a[60:63], a[252:255], v[224:227]
    global_load_dwordx4 a[28:31], v250, s[40:41] offset:384 sc1
    v_fmac_f32 v240, v68, v212
    v_mfma_f32_16x16x32_bf16 v[192:195], a[144:147], v[144:147], 0
    ds_read_b128 v[236:239], v251 offset:768
    v_fmac_f32 v241, v69, v213
    v_mfma_f32_16x16x32_bf16 v[192:195], a[148:151], v[148:151], v[192:195]
    v_cvt_pk_bf16_f32 v162, v240, v241
    v_fmac_f32 v242, v70, v214
    v_mfma_f32_16x16x32_bf16 v[192:195], a[152:155], v[152:155], v[192:195]
    v_fmac_f32 v243, v71, v215
    v_cvt_pk_bf16_f32 v163, v242, v243
    v_mfma_f32_16x16x32_bf16 v[192:195], a[156:159], v[156:159], v[192:195]
    global_load_dwordx4 a[32:35], v250, s[42:43] offset:-4096 sc1
    v_lshlrev_b32 v240, 16, v178
    v_mfma_f32_16x16x32_bf16 v[228:231], a[48:51], a[224:227], v[252:255]
    v_and_b32 v241, s84, v178
    v_lshlrev_b32 v242, 16, v179
    v_mfma_f32_16x16x32_bf16 v[228:231], a[52:55], a[228:231], v[228:231]
    v_and_b32 v243, s84, v179
    v_fmac_f32 v240, v100, v204
    v_mfma_f32_16x16x32_bf16 v[228:231], a[56:59], a[232:235], v[228:231]
    ds_write_b128 v245, v[160:163] offset:8704
    v_mfma_f32_16x16x32_bf16 v[228:231], a[60:63], a[236:239], v[228:231]
    s_waitcnt vmcnt(12) lgkmcnt(2)
    global_load_dwordx4 a[36:39], v250, s[42:43] offset:-3968 sc1
    v_fmac_f32 v241, v101, v205
    v_mfma_f32_16x16x32_bf16 v[208:211], a[160:163], a[208:211], v[208:211]
    v_cvt_pk_bf16_f32 v178, v240, v241
    v_fmac_f32 v242, v102, v206
    v_mfma_f32_16x16x32_bf16 v[208:211], a[164:167], a[212:215], v[208:211]
    v_fmac_f32 v243, v103, v207
    v_cvt_pk_bf16_f32 v179, v242, v243
    v_mfma_f32_16x16x32_bf16 v[208:211], a[168:171], a[216:219], v[208:211]
    v_lshlrev_b32 v240, 16, v164
    v_and_b32 v241, s84, v164
    v_mfma_f32_16x16x32_bf16 v[208:211], a[172:175], a[220:223], v[208:211]
    s_waitcnt vmcnt(12) lgkmcnt(1)
    global_load_dwordx4 a[40:43], v250, s[42:43] offset:-3840 sc1
    v_lshlrev_b32 v242, 16, v165
    v_mfma_f32_16x16x32_bf16 v[212:215], a[64:67], a[240:243], v[236:239]
    ds_write_b128 v245, v[176:179] offset:12800
    v_mfma_f32_16x16x32_bf16 v[212:215], a[68:71], a[244:247], v[212:215]
    v_fmac_f32 v240, v72, v196
    v_and_b32 v243, s84, v165
    v_mfma_f32_16x16x32_bf16 v[212:215], a[72:75], a[248:251], v[212:215]
    v_fmac_f32 v241, v73, v197
    v_cvt_pk_bf16_f32 v164, v240, v241
    v_mfma_f32_16x16x32_bf16 v[212:215], a[76:79], a[252:255], v[212:215]
    global_load_dwordx4 a[44:47], v250, s[42:43] offset:-3712 sc1
    v_fmac_f32 v242, v74, v198
    v_mfma_f32_16x16x32_bf16 v[220:223], a[176:179], a[208:211], v[220:223]
    v_fmac_f32 v243, v75, v199
    v_cvt_pk_bf16_f32 v165, v242, v243
    v_mfma_f32_16x16x32_bf16 v[220:223], a[180:183], a[212:215], v[220:223]
    s_waitcnt vmcnt(13) lgkmcnt(1)
    v_lshlrev_b32 v240, 16, v180
    v_and_b32 v241, s84, v180
    v_mfma_f32_16x16x32_bf16 v[220:223], a[184:187], a[216:219], v[220:223]
    s_waitcnt vmcnt(12)
    v_lshlrev_b32 v242, 16, v181
    v_fmac_f32 v240, v104, v216
    v_mfma_f32_16x16x32_bf16 v[220:223], a[188:191], a[220:223], v[220:223]
    global_load_dwordx4 a[48:51], v250, s[42:43] offset:0 sc1
    v_and_b32 v243, s84, v181
    v_mfma_f32_16x16x32_bf16 v[204:207], a[64:67], a[224:227], v[236:239]
    ds_read_b128 v[232:235], v251 offset:784
    v_fmac_f32 v241, v105, v217
    v_mfma_f32_16x16x32_bf16 v[204:207], a[68:71], a[228:231], v[204:207]
    v_cvt_pk_bf16_f32 v180, v240, v241
    v_fmac_f32 v242, v106, v218
    v_mfma_f32_16x16x32_bf16 v[204:207], a[72:75], a[232:235], v[204:207]
    v_fmac_f32 v243, v107, v219
    v_cvt_pk_bf16_f32 v181, v242, v243
    v_mfma_f32_16x16x32_bf16 v[204:207], a[76:79], a[236:239], v[204:207]
    global_load_dwordx4 a[52:55], v250, s[42:43] offset:128 sc1
    v_lshlrev_b32 v240, 16, v166
    v_mfma_f32_16x16x32_bf16 v[200:203], a[160:163], a[192:195], v[200:203]
    v_and_b32 v241, s84, v166
    v_lshlrev_b32 v242, 16, v167
    v_mfma_f32_16x16x32_bf16 v[200:203], a[164:167], a[196:199], v[200:203]
    v_fmac_f32 v240, v76, v224
    v_fmac_f32 v241, v77, v225
    v_mfma_f32_16x16x32_bf16 v[200:203], a[168:171], a[200:203], v[200:203]
    v_and_b32 v243, s84, v167
    v_cvt_pk_bf16_f32 v166, v240, v241
    v_mfma_f32_16x16x32_bf16 v[200:203], a[172:175], a[204:207], v[200:203]
    s_waitcnt vmcnt(12) lgkmcnt(0)
    v_fmac_f32 v242, v78, v226
    v_fmac_f32 v243, v79, v227
    v_mfma_f32_16x16x32_bf16 v[196:199], a[80:83], a[240:243], v[232:235]
    global_load_dwordx4 a[56:59], v250, s[42:43] offset:256 sc1
    v_cvt_pk_bf16_f32 v167, v242, v243
    v_mfma_f32_16x16x32_bf16 v[196:199], a[84:87], a[244:247], v[196:199]
    ds_write_b128 v245, v[164:167] offset:9728
    v_mfma_f32_16x16x32_bf16 v[196:199], a[88:91], a[248:251], v[196:199]
    v_lshlrev_b32 v240, 16, v182
    v_and_b32 v241, s84, v182
    v_mfma_f32_16x16x32_bf16 v[196:199], a[92:95], a[252:255], v[196:199]
    v_lshlrev_b32 v242, 16, v183
    v_and_b32 v243, s84, v183
    v_mfma_f32_16x16x32_bf16 v[192:195], a[176:179], a[192:195], v[192:195]
    ds_read_b128 v[252:255], v251 offset:896
    global_load_dwordx4 a[60:63], v250, s[42:43] offset:384 sc1
    v_mfma_f32_16x16x32_bf16 v[192:195], a[180:183], a[196:199], v[192:195]
    ds_read_b128 a[208:211], v247 offset:0
    ds_read_b128 a[212:215], v247 offset:1024
    v_mfma_f32_16x16x32_bf16 v[192:195], a[184:187], a[200:203], v[192:195]
    ds_read_b128 a[216:219], v247 offset:2048
    v_fmac_f32 v240, v108, v228
    v_mfma_f32_16x16x32_bf16 v[192:195], a[188:191], a[204:207], v[192:195]
    ds_read_b128 a[220:223], v247 offset:3072
    v_add_u32 v250, 0x20000, v250
    v_mfma_f32_16x16x32_bf16 v[216:219], a[80:83], a[224:227], v[232:235]
    global_load_dwordx4 a[64:67], v250, s[36:37] offset:-4096 sc1
    v_fmac_f32 v241, v109, v229
    v_mfma_f32_16x16x32_bf16 v[216:219], a[84:87], a[228:231], v[216:219]
    v_cvt_pk_bf16_f32 v182, v240, v241
    v_fmac_f32 v242, v110, v230
    v_mfma_f32_16x16x32_bf16 v[216:219], a[88:91], a[232:235], v[216:219]
    v_fmac_f32 v243, v111, v231
    v_cvt_pk_bf16_f32 v183, v242, v243
    v_mfma_f32_16x16x32_bf16 v[216:219], a[92:95], a[236:239], v[216:219]
    s_waitcnt vmcnt(12) lgkmcnt(3)
    v_lshlrev_b32 v240, 16, v168
    v_and_b32 v241, s84, v168
    v_mfma_f32_16x16x32_bf16 v[208:211], a[0:3], a[208:211], v[208:211]
    s_waitcnt lgkmcnt(2)
    global_load_dwordx4 a[68:71], v250, s[36:37] offset:-3968 sc1
    v_lshlrev_b32 v242, 16, v169
    v_and_b32 v243, s84, v169
    v_mfma_f32_16x16x32_bf16 v[208:211], a[4:7], a[212:215], v[208:211]
    s_waitcnt lgkmcnt(1)
    ds_write_b128 v245, v[180:183] offset:13824
    v_mfma_f32_16x16x32_bf16 v[208:211], a[8:11], a[216:219], v[208:211]
    s_waitcnt lgkmcnt(1)
    v_fmac_f32 v240, v80, v212
    v_fmac_f32 v241, v81, v213
    v_mfma_f32_16x16x32_bf16 v[208:211], a[12:15], a[220:223], v[208:211]
    v_cvt_pk_bf16_f32 v168, v240, v241
    v_fmac_f32 v242, v82, v214
    v_mfma_f32_16x16x32_bf16 v[224:227], a[96:99], a[240:243], v[252:255]
    global_load_dwordx4 a[72:75], v250, s[36:37] offset:-3840 sc1
    v_fmac_f32 v243, v83, v215
    v_cvt_pk_bf16_f32 v169, v242, v243
    v_mfma_f32_16x16x32_bf16 v[224:227], a[100:103], a[244:247], v[224:227]
    v_lshlrev_b32 v240, 16, v184
    v_and_b32 v241, s84, v184
    v_mfma_f32_16x16x32_bf16 v[224:227], a[104:107], a[248:251], v[224:227]
    ds_read_b128 v[236:239], v251 offset:912
    v_lshlrev_b32 v242, 16, v185
    v_and_b32 v243, s84, v185
    v_mfma_f32_16x16x32_bf16 v[224:227], a[108:111], a[252:255], v[224:227]
    v_fmac_f32 v240, v112, v204
    v_fmac_f32 v241, v113, v205
    v_mfma_f32_16x16x32_bf16 v[220:223], a[16:19], a[208:211], v[220:223]
    s_waitcnt vmcnt(12)
    global_load_dwordx4 a[76:79], v250, s[36:37] offset:-3712 sc1
    v_cvt_pk_bf16_f32 v184, v240, v241
    v_mfma_f32_16x16x32_bf16 v[220:223], a[20:23], a[212:215], v[220:223]
    ds_read_b128 a[192:195], v247 offset:4096
    v_fmac_f32 v242, v114, v206
    v_fmac_f32 v243, v115, v207
    v_mfma_f32_16x16x32_bf16 v[220:223], a[24:27], a[216:219], v[220:223]
    s_waitcnt vmcnt(12) lgkmcnt(2)
    ds_read_b128 a[196:199], v247 offset:5120
    v_cvt_pk_bf16_f32 v185, v242, v243
    v_mfma_f32_16x16x32_bf16 v[220:223], a[28:31], a[220:223], v[220:223]
    ds_read_b128 a[200:203], v247 offset:6144
    v_lshlrev_b32 v240, 16, v170
    v_and_b32 v241, s84, v170
    v_mfma_f32_16x16x32_bf16 v[228:231], a[96:99], a[224:227], v[252:255]
    ds_read_b128 a[204:207], v247 offset:7168
    global_load_dwordx4 a[80:83], v250, s[36:37] offset:0 sc1
    v_mfma_f32_16x16x32_bf16 v[228:231], a[100:103], a[228:231], v[228:231]
    v_lshlrev_b32 v242, 16, v171
    v_and_b32 v243, s84, v171
    v_mfma_f32_16x16x32_bf16 v[228:231], a[104:107], a[232:235], v[228:231]
    v_fmac_f32 v240, v84, v196
    v_fmac_f32 v241, v85, v197
    v_cvt_pk_bf16_f32 v170, v240, v241
    v_mfma_f32_16x16x32_bf16 v[228:231], a[108:111], a[236:239], v[228:231]
    s_waitcnt vmcnt(12) lgkmcnt(3)
    v_fmac_f32 v242, v86, v198
    v_fmac_f32 v243, v87, v199
    v_mfma_f32_16x16x32_bf16 v[200:203], a[0:3], a[192:195], v[200:203]
    s_waitcnt lgkmcnt(2)
    global_load_dwordx4 a[84:87], v250, s[36:37] offset:128 sc1
    v_cvt_pk_bf16_f32 v171, v242, v243
    v_lshlrev_b32 v240, 16, v186
    v_mfma_f32_16x16x32_bf16 v[200:203], a[4:7], a[196:199], v[200:203]
    s_waitcnt lgkmcnt(1)
    v_and_b32 v241, s84, v186
    v_lshlrev_b32 v242, 16, v187
    v_mfma_f32_16x16x32_bf16 v[200:203], a[8:11], a[200:203], v[200:203]
    s_waitcnt lgkmcnt(0)
    ds_write_b128 v245, v[168:171] offset:10752
    v_mfma_f32_16x16x32_bf16 v[200:203], a[12:15], a[204:207], v[200:203]
    v_fmac_f32 v240, v116, v216
    v_fmac_f32 v241, v117, v217
    v_and_b32 v243, s84, v187
    v_mfma_f32_16x16x32_bf16 v[212:215], a[112:115], a[240:243], v[236:239]
    global_load_dwordx4 a[88:91], v250, s[36:37] offset:256 sc1
    v_cvt_pk_bf16_f32 v186, v240, v241
    v_mfma_f32_16x16x32_bf16 v[212:215], a[116:119], a[244:247], v[212:215]
    v_fmac_f32 v242, v118, v218
    v_fmac_f32 v243, v119, v219
    v_cvt_pk_bf16_f32 v187, v242, v243
    v_mfma_f32_16x16x32_bf16 v[212:215], a[120:123], a[248:251], v[212:215]
    ds_write_b128 v245, v[184:187] offset:14848
    v_mfma_f32_16x16x32_bf16 v[212:215], a[124:127], a[252:255], v[212:215]
    v_lshlrev_b32 v240, 16, v172
    v_and_b32 v241, s84, v172
    v_mfma_f32_16x16x32_bf16 v[192:195], a[16:19], a[192:195], v[192:195]
    global_load_dwordx4 a[92:95], v250, s[36:37] offset:384 sc1
    v_lshlrev_b32 v242, 16, v173
    v_mfma_f32_16x16x32_bf16 v[192:195], a[20:23], a[196:199], v[192:195]
    ds_read_b128 a[208:211], v248 offset:0
    v_fmac_f32 v240, v88, v224
    v_mfma_f32_16x16x32_bf16 v[192:195], a[24:27], a[200:203], v[192:195]
    ds_read_b128 a[212:215], v248 offset:1024
    v_and_b32 v243, s84, v173
    v_mfma_f32_16x16x32_bf16 v[192:195], a[28:31], a[204:207], v[192:195]
    ds_read_b128 a[216:219], v248 offset:2048
    v_fmac_f32 v241, v89, v225
    v_mfma_f32_16x16x32_bf16 v[204:207], a[112:115], a[224:227], v[236:239]
    ds_read_b128 a[220:223], v248 offset:3072
    global_load_dwordx4 a[96:99], v250, s[38:39] offset:-4096 sc1
    v_mfma_f32_16x16x32_bf16 v[204:207], a[116:119], a[228:231], v[204:207]
    v_cvt_pk_bf16_f32 v172, v240, v241
    v_fmac_f32 v242, v90, v226
    v_fmac_f32 v243, v91, v227
    v_mfma_f32_16x16x32_bf16 v[204:207], a[120:123], a[232:235], v[204:207]
    v_cvt_pk_bf16_f32 v173, v242, v243
    v_lshlrev_b32 v240, 16, v188
    v_mfma_f32_16x16x32_bf16 v[204:207], a[124:127], a[236:239], v[204:207]
    s_waitcnt vmcnt(12) lgkmcnt(3)
    v_and_b32 v241, s84, v188
    v_lshlrev_b32 v242, 16, v189
    v_and_b32 v243, s84, v189
    v_mfma_f32_16x16x32_bf16 v[208:211], a[32:35], a[208:211], v[208:211]
    s_waitcnt lgkmcnt(2)
    global_load_dwordx4 a[100:103], v250, s[38:39] offset:-3968 sc1
    v_fmac_f32 v240, v120, v228
    v_mfma_f32_16x16x32_bf16 v[208:211], a[36:39], a[212:215], v[208:211]
    s_waitcnt lgkmcnt(1)
    ds_read_b128 a[240:243], v248 offset:4096
    v_fmac_f32 v241, v121, v229
    v_mfma_f32_16x16x32_bf16 v[208:211], a[40:43], a[216:219], v[208:211]
    s_waitcnt lgkmcnt(1)
    ds_read_b128 a[244:247], v248 offset:5120
    v_cvt_pk_bf16_f32 v188, v240, v241
    v_fmac_f32 v242, v122, v230
    v_mfma_f32_16x16x32_bf16 v[208:211], a[44:47], a[220:223], v[208:211]
    ds_read_b128 a[248:251], v248 offset:6144
    v_fmac_f32 v243, v123, v231
    v_mfma_f32_16x16x32_bf16 v[220:223], a[48:51], a[208:211], v[220:223]
    s_waitcnt vmcnt(12)
    ds_read_b128 a[252:255], v248 offset:7168
    global_load_dwordx4 a[104:107], v250, s[38:39] offset:-3840 sc1
    v_cvt_pk_bf16_f32 v189, v242, v243
    v_mfma_f32_16x16x32_bf16 v[220:223], a[52:55], a[212:215], v[220:223]
    s_waitcnt vmcnt(12)
    v_lshlrev_b32 v240, 16, v174
    v_and_b32 v241, s84, v174
    v_mfma_f32_16x16x32_bf16 v[220:223], a[56:59], a[216:219], v[220:223]
    s_waitcnt vmcnt(11)
    v_lshlrev_b32 v242, 16, v175
    v_and_b32 v243, s84, v175
    v_mfma_f32_16x16x32_bf16 v[220:223], a[60:63], a[220:223], v[220:223]
    s_waitcnt lgkmcnt(3)
    v_fmac_f32 v240, v92, v212
    v_fmac_f32 v241, v93, v213
    v_cvt_pk_bf16_f32 v174, v240, v241
    v_mfma_f32_16x16x32_bf16 v[200:203], a[32:35], a[240:243], v[200:203]
    s_waitcnt lgkmcnt(2)
    global_load_dwordx4 a[108:111], v250, s[38:39] offset:-3712 sc1
    v_fmac_f32 v242, v94, v214
    v_mfma_f32_16x16x32_bf16 v[200:203], a[36:39], a[244:247], v[200:203]
    s_waitcnt lgkmcnt(1)
    v_fmac_f32 v243, v95, v215
    v_cvt_pk_bf16_f32 v175, v242, v243
    v_lshlrev_b32 v240, 16, v190
    v_mfma_f32_16x16x32_bf16 v[200:203], a[40:43], a[248:251], v[200:203]
    s_waitcnt lgkmcnt(0)
    v_and_b32 v241, s84, v190
    v_lshlrev_b32 v242, 16, v191
    v_mfma_f32_16x16x32_bf16 v[200:203], a[44:47], a[252:255], v[200:203]
    ds_write_b128 v245, v[172:175] offset:11776
    v_mfma_f32_16x16x32_bf16 v[192:195], a[48:51], a[240:243], v[192:195]
    global_load_dwordx4 a[112:115], v250, s[38:39] offset:0 sc1
    v_fmac_f32 v240, v124, v204
    v_and_b32 v243, s84, v191
    v_mfma_f32_16x16x32_bf16 v[192:195], a[52:55], a[244:247], v[192:195]
    v_fmac_f32 v241, v125, v205
    v_cvt_pk_bf16_f32 v190, v240, v241
    v_mfma_f32_16x16x32_bf16 v[192:195], a[56:59], a[248:251], v[192:195]
    v_fmac_f32 v242, v126, v206
    v_fmac_f32 v243, v127, v207
    v_cvt_pk_bf16_f32 v191, v242, v243
    v_mfma_f32_16x16x32_bf16 v[192:195], a[60:63], a[252:255], v[192:195]
    ds_write_b128 v245, v[188:191] offset:15872
    v_mfma_f32_16x16x32_bf16 v[196:199], a[128:131], v[160:163], 0
    global_load_dwordx4 a[116:119], v250, s[38:39] offset:128 sc1
    v_cvt_pk_bf16_f32 v208, v208, v209
    v_mfma_f32_16x16x32_bf16 v[196:199], a[132:135], v[164:167], v[196:199]
    v_cvt_pk_bf16_f32 v209, v210, v211
    v_cvt_pk_bf16_f32 v210, v220, v221
    v_mfma_f32_16x16x32_bf16 v[196:199], a[136:139], v[168:171], v[196:199]
    v_cvt_pk_bf16_f32 v211, v222, v223
    v_cvt_pk_bf16_f32 v200, v200, v201
    v_mfma_f32_16x16x32_bf16 v[196:199], a[140:143], v[172:175], v[196:199]
    ds_write_b128 v245, v[208:211] offset:17408
    v_mfma_f32_16x16x32_bf16 v[216:219], a[144:147], v[160:163], 0
    global_load_dwordx4 a[120:123], v250, s[38:39] offset:256 sc1
    v_cvt_pk_bf16_f32 v201, v202, v203
    v_mfma_f32_16x16x32_bf16 v[216:219], a[148:151], v[164:167], v[216:219]
    v_cvt_pk_bf16_f32 v202, v192, v193
    v_cvt_pk_bf16_f32 v203, v194, v195
    v_mfma_f32_16x16x32_bf16 v[216:219], a[152:155], v[168:171], v[216:219]
    ds_write_b128 v245, v[200:203] offset:18432
    v_mfma_f32_16x16x32_bf16 v[216:219], a[156:159], v[172:175], v[216:219]
    s_waitcnt vmcnt(13) lgkmcnt(2)
    s_barrier
    v_lshrrev_b32 v212, 3, v249
    v_mfma_f32_16x16x32_bf16 v[224:227], a[128:131], v[176:179], 0
    global_load_dwordx4 a[124:127], v250, s[38:39] offset:384 sc1
    v_and_b32 v212, 0x30, v212
    v_mfma_f32_16x16x32_bf16 v[224:227], a[132:135], v[180:183], v[224:227]
    ds_read_b128 a[192:195], v246 offset:8704
    ds_read_b128 a[196:199], v246 offset:9728
    v_mfma_f32_16x16x32_bf16 v[224:227], a[136:139], v[184:187], v[224:227]
    ds_read_b128 a[200:203], v246 offset:10752
    ds_read_b128 a[204:207], v246 offset:11776
    v_mfma_f32_16x16x32_bf16 v[224:227], a[140:143], v[188:191], v[224:227]
    ds_read_b128 v[232:235], v251 offset:1024
    ds_read_b128 a[224:227], v245 offset:17408
    v_mfma_f32_16x16x32_bf16 v[228:231], a[144:147], v[176:179], 0
    global_load_dwordx4 a[128:131], v250, s[40:41] offset:-4096 sc1
    v_xor_b32 v212, v212, v249
    v_mfma_f32_16x16x32_bf16 v[228:231], a[148:151], v[180:183], v[228:231]
    s_waitcnt vmcnt(13) lgkmcnt(6)
    s_barrier
    ds_read_b128 a[228:231], v246 offset:17408
    v_mfma_f32_16x16x32_bf16 v[228:231], a[152:155], v[184:187], v[228:231]
    ds_read_b128 a[232:235], v247 offset:17408
    ds_read_b128 a[236:239], v248 offset:17408
    v_mfma_f32_16x16x32_bf16 v[228:231], a[156:159], v[188:191], v[228:231]
    s_waitcnt lgkmcnt(8)
    ds_read_b128 a[208:211], v246 offset:12800
    v_and_b32 v212, 0x70, v212
    v_mfma_f32_16x16x32_bf16 v[196:199], a[160:163], a[192:195], v[196:199]
    s_waitcnt vmcnt(12) lgkmcnt(8)
    global_load_dwordx4 a[132:135], v250, s[40:41] offset:-3968 sc1
    ds_read_b128 a[212:215], v246 offset:13824
    v_mfma_f32_16x16x32_bf16 v[196:199], a[164:167], a[196:199], v[196:199]
    s_waitcnt lgkmcnt(8)
    v_lshrrev_b32 v249, 7, v249
    v_lshl_add_u32 v249, v249, 10, v212
    v_mfma_f32_16x16x32_bf16 v[196:199], a[168:171], a[200:203], v[196:199]
    s_waitcnt lgkmcnt(7)
    ds_read_b128 a[216:219], v246 offset:14848
    ds_read_b128 a[220:223], v246 offset:15872
    v_mfma_f32_16x16x32_bf16 v[196:199], a[172:175], a[204:207], v[196:199]
    ds_read_b128 a[240:243], v245 offset:18432
    ds_read_b128 a[244:247], v246 offset:18432
    v_mfma_f32_16x16x32_bf16 v[216:219], a[176:179], a[192:195], v[216:219]
    global_load_dwordx4 a[136:139], v250, s[40:41] offset:-3840 sc1
    ds_read_b128 a[248:251], v247 offset:18432
    v_mfma_f32_16x16x32_bf16 v[216:219], a[180:183], a[196:199], v[216:219]
    ds_read_b128 a[252:255], v248 offset:18432
    ds_read_b128 v[252:255], v251 offset:1040
    v_mfma_f32_16x16x32_bf16 v[216:219], a[184:187], a[200:203], v[216:219]
    ds_read_b128 v[236:239], v251 offset:1152
    ds_read_b128 a[192:195], v247 offset:8704
    v_mfma_f32_16x16x32_bf16 v[216:219], a[188:191], a[204:207], v[216:219]
    s_waitcnt vmcnt(13) lgkmcnt(10)
    ds_read_b128 a[196:199], v247 offset:9728
    v_lshlrev_b32 v240, 16, v128
    v_mfma_f32_16x16x32_bf16 v[212:215], a[64:67], a[224:227], v[232:235]
    global_load_dwordx4 a[140:143], v250, s[40:41] offset:-3712 sc1
    v_and_b32 v241, s84, v128
    v_mfma_f32_16x16x32_bf16 v[212:215], a[68:71], a[228:231], v[212:215]
    ds_read_b128 a[200:203], v247 offset:10752
    v_lshlrev_b32 v242, 16, v129
    v_mfma_f32_16x16x32_bf16 v[212:215], a[72:75], a[232:235], v[212:215]
    ds_read_b128 a[204:207], v247 offset:11776
    v_and_b32 v243, s84, v129
    v_mfma_f32_16x16x32_bf16 v[212:215], a[76:79], a[236:239], v[212:215]
    v_add_u32 v249, s72, v249
    v_mfma_f32_16x16x32_bf16 v[224:227], a[160:163], a[208:211], v[224:227]
    s_waitcnt vmcnt(12) lgkmcnt(7)
    global_load_dwordx4 a[144:147], v250, s[40:41] offset:0 sc1
    v_mfma_f32_16x16x32_bf16 v[224:227], a[164:167], a[212:215], v[224:227]
    v_mfma_f32_16x16x32_bf16 v[224:227], a[168:171], a[216:219], v[224:227]
    v_fmac_f32 v240, v0, v212
    v_fmac_f32 v241, v1, v213
    v_mfma_f32_16x16x32_bf16 v[224:227], a[172:175], a[220:223], v[224:227]
    v_cvt_pk_bf16_f32 v128, v240, v241
    v_fmac_f32 v242, v2, v214
    v_mfma_f32_16x16x32_bf16 v[204:207], a[64:67], a[240:243], v[232:235]
    global_load_dwordx4 a[148:151], v250, s[40:41] offset:128 sc1
    v_fmac_f32 v243, v3, v215
    v_mfma_f32_16x16x32_bf16 v[204:207], a[68:71], a[244:247], v[204:207]
    v_cvt_pk_bf16_f32 v129, v242, v243
    v_lshlrev_b32 v240, 16, v144
    v_mfma_f32_16x16x32_bf16 v[204:207], a[72:75], a[248:251], v[204:207]
    s_waitcnt vmcnt(13) lgkmcnt(0)
    v_and_b32 v241, s84, v144
    v_lshlrev_b32 v242, 16, v145
    v_mfma_f32_16x16x32_bf16 v[204:207], a[76:79], a[252:255], v[204:207]
    ds_read_b128 v[232:235], v251 offset:1168
    v_and_b32 v243, s84, v145
    v_mfma_f32_16x16x32_bf16 v[228:231], a[176:179], a[208:211], v[228:231]
    global_load_dwordx4 a[152:155], v250, s[40:41] offset:256 sc1
    ds_read_b128 a[208:211], v247 offset:12800
    v_mfma_f32_16x16x32_bf16 v[228:231], a[180:183], a[212:215], v[228:231]
    ds_read_b128 a[212:215], v247 offset:13824
    v_mfma_f32_16x16x32_bf16 v[228:231], a[184:187], a[216:219], v[228:231]
    v_fmac_f32 v240, v32, v204
    v_fmac_f32 v241, v33, v205
    v_mfma_f32_16x16x32_bf16 v[228:231], a[188:191], a[220:223], v[228:231]
    v_cvt_pk_bf16_f32 v144, v240, v241
    v_fmac_f32 v242, v34, v206
    v_mfma_f32_16x16x32_bf16 v[220:223], a[80:83], a[224:227], v[252:255]
    global_load_dwordx4 a[156:159], v250, s[40:41] offset:384 sc1
    v_fmac_f32 v243, v35, v207
    v_mfma_f32_16x16x32_bf16 v[220:223], a[84:87], a[228:231], v[220:223]
    v_cvt_pk_bf16_f32 v145, v242, v243
    v_lshlrev_b32 v240, 16, v130
    v_mfma_f32_16x16x32_bf16 v[220:223], a[88:91], a[232:235], v[220:223]
    v_and_b32 v241, s84, v130
    v_lshlrev_b32 v242, 16, v131
    v_mfma_f32_16x16x32_bf16 v[220:223], a[92:95], a[236:239], v[220:223]
    ds_read_b128 a[216:219], v247 offset:14848
    v_and_b32 v243, s84, v131
    v_mfma_f32_16x16x32_bf16 v[196:199], a[0:3], a[192:195], v[196:199]
L_st3:
    s_cbranch_execz L_wret
    global_load_dwordx4 a[160:163], v250, s[42:43] offset:-4096 sc1
    ds_read_b128 a[220:223], v247 offset:15872
    v_mfma_f32_16x16x32_bf16 v[196:199], a[4:7], a[196:199], v[196:199]
    v_mfma_f32_16x16x32_bf16 v[196:199], a[8:11], a[200:203], v[196:199]
    v_fmac_f32 v240, v4, v220
    v_fmac_f32 v241, v5, v221
    v_mfma_f32_16x16x32_bf16 v[196:199], a[12:15], a[204:207], v[196:199]
    v_cvt_pk_bf16_f32 v130, v240, v241
    v_fmac_f32 v242, v6, v222
    v_mfma_f32_16x16x32_bf16 v[208:211], a[80:83], a[240:243], v[252:255]
    global_load_dwordx4 a[164:167], v250, s[42:43] offset:-3968 sc1
    v_fmac_f32 v243, v7, v223
    v_mfma_f32_16x16x32_bf16 v[208:211], a[84:87], a[244:247], v[208:211]
    v_cvt_pk_bf16_f32 v131, v242, v243
    v_lshlrev_b32 v240, 16, v146
    v_mfma_f32_16x16x32_bf16 v[208:211], a[88:91], a[248:251], v[208:211]
    v_and_b32 v241, s84, v146
    v_lshlrev_b32 v242, 16, v147
    v_mfma_f32_16x16x32_bf16 v[208:211], a[92:95], a[252:255], v[208:211]
    ds_write_b128 v244, v[128:131] offset:0
    v_mfma_f32_16x16x32_bf16 v[216:219], a[16:19], a[192:195], v[216:219]
    global_load_dwordx4 a[168:171], v250, s[42:43] offset:-3840 sc1
    v_and_b32 v243, s84, v147
    v_mfma_f32_16x16x32_bf16 v[216:219], a[20:23], a[196:199], v[216:219]
    v_mfma_f32_16x16x32_bf16 v[216:219], a[24:27], a[200:203], v[216:219]
    v_fmac_f32 v240, v36, v208
    v_fmac_f32 v241, v37, v209
    v_cvt_pk_bf16_f32 v146, v240, v241
    v_mfma_f32_16x16x32_bf16 v[216:219], a[28:31], a[204:207], v[216:219]
    v_fmac_f32 v242, v38, v210
    v_fmac_f32 v243, v39, v211
    v_cvt_pk_bf16_f32 v147, v242, v243
    v_mfma_f32_16x16x32_bf16 v[192:195], a[96:99], a[224:227], v[236:239]
    s_waitcnt vmcnt(12) lgkmcnt(1)
    ds_write_b128 v244, v[144:147] offset:4480
    v_mfma_f32_16x16x32_bf16 v[192:195], a[100:103], a[228:231], v[192:195]
    global_load_dwordx4 a[172:175], v250, s[42:43] offset:-3712 sc1
    v_lshlrev_b32 v240, 16, v132
    v_mfma_f32_16x16x32_bf16 v[192:195], a[104:107], a[232:235], v[192:195]
    ds_read_b128 v[252:255], v251 offset:1280
    v_and_b32 v241, s84, v132
    v_mfma_f32_16x16x32_bf16 v[192:195], a[108:111], a[236:239], v[192:195]
    ds_read_b128 a[192:195], v248 offset:8704
    ds_read_b128 a[196:199], v248 offset:9728
    v_mfma_f32_16x16x32_bf16 v[224:227], a[0:3], a[208:211], v[224:227]
    ds_read_b128 a[200:203], v248 offset:10752
    v_lshlrev_b32 v242, 16, v133
    v_mfma_f32_16x16x32_bf16 v[224:227], a[4:7], a[212:215], v[224:227]
    global_load_dwordx4 a[176:179], v250, s[42:43] offset:0 sc1
    v_and_b32 v243, s84, v133
    v_mfma_f32_16x16x32_bf16 v[224:227], a[8:11], a[216:219], v[224:227]
    ds_read_b128 a[204:207], v248 offset:11776
    v_fmac_f32 v240, v8, v192
    v_mfma_f32_16x16x32_bf16 v[224:227], a[12:15], a[220:223], v[224:227]
    v_fmac_f32 v241, v9, v193
    v_cvt_pk_bf16_f32 v132, v240, v241
    v_mfma_f32_16x16x32_bf16 v[200:203], a[96:99], a[240:243], v[236:239]
    v_fmac_f32 v242, v10, v194
    v_fmac_f32 v243, v11, v195
    v_mfma_f32_16x16x32_bf16 v[200:203], a[100:103], a[244:247], v[200:203]
    global_load_dwordx4 a[180:183], v250, s[42:43] offset:128 sc1
    v_cvt_pk_bf16_f32 v133, v242, v243
    v_mfma_f32_16x16x32_bf16 v[200:203], a[104:107], a[248:251], v[200:203]
    v_lshlrev_b32 v240, 16, v148
    v_and_b32 v241, s84, v148
    v_mfma_f32_16x16x32_bf16 v[200:203], a[108:111], a[252:255], v[200:203]
    v_lshlrev_b32 v242, 16, v149
    v_and_b32 v243, s84, v149
    v_mfma_f32_16x16x32_bf16 v[228:231], a[16:19], a[208:211], v[228:231]
    ds_read_b128 a[208:211], v248 offset:12800
    ds_read_b128 v[236:239], v251 offset:1296
    v_mfma_f32_16x16x32_bf16 v[228:231], a[20:23], a[212:215], v[228:231]
    global_load_dwordx4 a[184:187], v250, s[42:43] offset:256 sc1
    ds_read_b128 a[212:215], v248 offset:13824
    v_mfma_f32_16x16x32_bf16 v[228:231], a[24:27], a[216:219], v[228:231]
    v_fmac_f32 v240, v40, v200
    v_fmac_f32 v241, v41, v201
    v_cvt_pk_bf16_f32 v148, v240, v241
    v_mfma_f32_16x16x32_bf16 v[228:231], a[28:31], a[220:223], v[228:231]
    v_fmac_f32 v242, v42, v202
    v_fmac_f32 v243, v43, v203
    v_mfma_f32_16x16x32_bf16 v[212:215], a[112:115], a[224:227], v[232:235]
    v_cvt_pk_bf16_f32 v149, v242, v243
    v_lshlrev_b32 v240, 16, v134
    v_and_b32 v241, s84, v134
    v_mfma_f32_16x16x32_bf16 v[212:215], a[116:119], a[228:231], v[212:215]
    global_load_dwordx4 a[188:191], v250, s[42:43] offset:384 sc1
    v_lshlrev_b32 v242, 16, v135
    v_mfma_f32_16x16x32_bf16 v[212:215], a[120:123], a[232:235], v[212:215]
    s_waitcnt vmcnt(13) lgkmcnt(3)
    v_and_b32 v243, s84, v135
    v_subrev_u32 v250, s81, v245
    v_lshrrev_b32 v250, 9, v250
    v_mfma_f32_16x16x32_bf16 v[212:215], a[124:127], a[236:239], v[212:215]
    v_lshl_add_u32 v250, v250, 6, v245
    v_add_u32 v250, s3, v250
    v_mfma_f32_16x16x32_bf16 v[196:199], a[32:35], a[192:195], v[196:199]
    ds_read_b128 a[216:219], v248 offset:14848
    ds_read_b128 a[220:223], v248 offset:15872
    v_mfma_f32_16x16x32_bf16 v[196:199], a[36:39], a[196:199], v[196:199]
    v_mfma_f32_16x16x32_bf16 v[196:199], a[40:43], a[200:203], v[196:199]
    v_fmac_f32 v240, v12, v212
    v_fmac_f32 v241, v13, v213
    v_cvt_pk_bf16_f32 v134, v240, v241
    v_mfma_f32_16x16x32_bf16 v[196:199], a[44:47], a[204:207], v[196:199]
    v_fmac_f32 v242, v14, v214
    v_fmac_f32 v243, v15, v215
    v_cvt_pk_bf16_f32 v135, v242, v243
    v_mfma_f32_16x16x32_bf16 v[204:207], a[112:115], a[240:243], v[232:235]
    ds_write_b128 v244, v[132:135] offset:64
    v_mfma_f32_16x16x32_bf16 v[204:207], a[116:119], a[244:247], v[204:207]
    ds_read_b128 a[0:3], v250 offset:0
    ds_read_b128 a[4:7], v250 offset:1152
    v_lshlrev_b32 v240, 16, v150
    v_mfma_f32_16x16x32_bf16 v[204:207], a[120:123], a[248:251], v[204:207]
    v_and_b32 v241, s84, v150
    v_lshlrev_b32 v242, 16, v151
    v_mfma_f32_16x16x32_bf16 v[204:207], a[124:127], a[252:255], v[204:207]
    ds_read_b128 v[232:235], v251 offset:1408
    v_and_b32 v243, s84, v151
    v_mfma_f32_16x16x32_bf16 v[216:219], a[48:51], a[192:195], v[216:219]
    v_cvt_pk_bf16_f32 v196, v196, v197
    v_cvt_pk_bf16_f32 v197, v198, v199
    v_mfma_f32_16x16x32_bf16 v[216:219], a[52:55], a[196:199], v[216:219]
    s_waitcnt vmcnt(10) lgkmcnt(2)
    buffer_store_dwordx4 a[0:3], v249, s[56:59], s64 offen offset:0 nt
    v_mfma_f32_16x16x32_bf16 v[216:219], a[56:59], a[200:203], v[216:219]
    s_waitcnt lgkmcnt(1)
    buffer_store_dwordx4 a[4:7], v249, s[56:59], s66 offen offset:0 nt
    v_mfma_f32_16x16x32_bf16 v[216:219], a[60:63], a[204:207], v[216:219]
    v_fmac_f32 v240, v44, v204
    v_fmac_f32 v241, v45, v205
    v_cvt_pk_bf16_f32 v150, v240, v241
    v_mfma_f32_16x16x32_bf16 v[220:223], a[128:131], a[224:227], v[252:255]
    v_fmac_f32 v242, v46, v206
    v_fmac_f32 v243, v47, v207
    v_cvt_pk_bf16_f32 v151, v242, v243
    v_mfma_f32_16x16x32_bf16 v[220:223], a[132:135], a[228:231], v[220:223]
    ds_write_b128 v244, v[148:151] offset:4544
    v_mfma_f32_16x16x32_bf16 v[220:223], a[136:139], a[232:235], v[220:223]
    ds_read_b128 a[8:11], v250 offset:4480
    v_lshlrev_b32 v240, 16, v136
    v_mfma_f32_16x16x32_bf16 v[220:223], a[140:143], a[236:239], v[220:223]
    ds_read_b128 a[12:15], v250 offset:5632
    v_and_b32 v241, s84, v136
    v_mfma_f32_16x16x32_bf16 v[224:227], a[32:35], a[208:211], v[224:227]
    v_lshlrev_b32 v242, 16, v137
    v_cvt_pk_bf16_f32 v198, v216, v217
    v_mfma_f32_16x16x32_bf16 v[224:227], a[36:39], a[212:215], v[224:227]
    v_cvt_pk_bf16_f32 v199, v218, v219
    v_and_b32 v243, s84, v137
    v_mfma_f32_16x16x32_bf16 v[224:227], a[40:43], a[216:219], v[224:227]
    s_waitcnt vmcnt(10) lgkmcnt(1)
    buffer_store_dwordx4 a[8:11], v249, s[56:59], s68 offen offset:0 nt
    v_mfma_f32_16x16x32_bf16 v[224:227], a[44:47], a[220:223], v[224:227]
    s_waitcnt lgkmcnt(0)
    buffer_store_dwordx4 a[12:15], v249, s[56:59], s70 offen offset:0 nt
    v_mfma_f32_16x16x32_bf16 v[208:211], a[128:131], a[240:243], v[252:255]
    ds_write_b128 v245, v[196:199] offset:19456
    v_mfma_f32_16x16x32_bf16 v[208:211], a[132:135], a[244:247], v[208:211]
    v_fmac_f32 v240, v16, v220
    v_fmac_f32 v241, v17, v221
    v_mfma_f32_16x16x32_bf16 v[208:211], a[136:139], a[248:251], v[208:211]
    v_cvt_pk_bf16_f32 v136, v240, v241
    v_fmac_f32 v242, v18, v222
    v_mfma_f32_16x16x32_bf16 v[208:211], a[140:143], a[252:255], v[208:211]
    v_fmac_f32 v243, v19, v223
    v_cvt_pk_bf16_f32 v137, v242, v243
    v_mfma_f32_16x16x32_bf16 v[228:231], a[48:51], a[208:211], v[228:231]
    v_lshlrev_b32 v240, 16, v152
    v_and_b32 v241, s84, v152
    v_mfma_f32_16x16x32_bf16 v[228:231], a[52:55], a[212:215], v[228:231]
    v_lshlrev_b32 v242, 16, v153
    v_and_b32 v243, s84, v153
    v_mfma_f32_16x16x32_bf16 v[228:231], a[56:59], a[216:219], v[228:231]
    ds_read_b128 v[252:255], v251 offset:1424
    v_cvt_pk_bf16_f32 v224, v224, v225
    v_mfma_f32_16x16x32_bf16 v[228:231], a[60:63], a[220:223], v[228:231]
    v_fmac_f32 v240, v48, v208
    v_cvt_pk_bf16_f32 v225, v226, v227
    v_mfma_f32_16x16x32_bf16 v[192:195], a[144:147], a[224:227], v[236:239]
    v_fmac_f32 v241, v49, v209
    v_cvt_pk_bf16_f32 v152, v240, v241
    v_mfma_f32_16x16x32_bf16 v[192:195], a[148:151], a[228:231], v[192:195]
    v_fmac_f32 v242, v50, v210
    v_fmac_f32 v243, v51, v211
    v_mfma_f32_16x16x32_bf16 v[192:195], a[152:155], a[232:235], v[192:195]
    v_cvt_pk_bf16_f32 v153, v242, v243
    v_lshlrev_b32 v240, 16, v138
    v_mfma_f32_16x16x32_bf16 v[192:195], a[156:159], a[236:239], v[192:195]
    v_and_b32 v241, s84, v138
    v_cvt_pk_bf16_f32 v226, v228, v229
    v_mfma_f32_16x16x32_bf16 v[200:203], a[144:147], a[240:243], v[236:239]
    v_cvt_pk_bf16_f32 v227, v230, v231
    v_lshlrev_b32 v242, 16, v139
    v_mfma_f32_16x16x32_bf16 v[200:203], a[148:151], a[244:247], v[200:203]
    ds_write_b128 v245, v[224:227] offset:20480
    v_mfma_f32_16x16x32_bf16 v[200:203], a[152:155], a[248:251], v[200:203]
    v_fmac_f32 v240, v20, v192
    v_and_b32 v243, s84, v139
    v_mfma_f32_16x16x32_bf16 v[200:203], a[156:159], a[252:255], v[200:203]
    s_waitcnt vmcnt(8) lgkmcnt(1)
    v_fmac_f32 v241, v21, v193
    v_cvt_pk_bf16_f32 v138, v240, v241
    v_fmac_f32 v242, v22, v194
    v_mfma_f32_16x16x32_bf16 v[212:215], a[160:163], a[224:227], v[232:235]
    v_fmac_f32 v243, v23, v195
    v_cvt_pk_bf16_f32 v139, v242, v243
    v_lshlrev_b32 v240, 16, v154
    v_and_b32 v241, s84, v154
    v_lshlrev_b32 v242, 16, v155
    v_and_b32 v243, s84, v155
    v_mfma_f32_16x16x32_bf16 v[212:215], a[164:167], a[228:231], v[212:215]
    ds_write_b128 v244, v[136:139] offset:2240
    v_mfma_f32_16x16x32_bf16 v[212:215], a[168:171], a[232:235], v[212:215]
    v_fmac_f32 v240, v52, v200
    v_fmac_f32 v241, v53, v201
    v_cvt_pk_bf16_f32 v154, v240, v241
    v_fmac_f32 v242, v54, v202
    v_fmac_f32 v243, v55, v203
    v_cvt_pk_bf16_f32 v155, v242, v243
    v_mfma_f32_16x16x32_bf16 v[212:215], a[172:175], a[236:239], v[212:215]
    ds_write_b128 v244, v[152:155] offset:6720
    v_mfma_f32_16x16x32_bf16 v[204:207], a[160:163], a[240:243], v[232:235]
    s_waitcnt vmcnt(7) lgkmcnt(2)
    s_barrier
    v_lshlrev_b32 v240, 16, v140
    v_mfma_f32_16x16x32_bf16 v[204:207], a[164:167], a[244:247], v[204:207]
    ds_read_b128 a[192:195], v245 offset:19456
    v_and_b32 v241, s84, v140
    v_mfma_f32_16x16x32_bf16 v[204:207], a[168:171], a[248:251], v[204:207]
    ds_read_b128 v[236:239], v251 offset:1024
    ds_read_b128 a[196:199], v246 offset:19456
    v_mfma_f32_16x16x32_bf16 v[204:207], a[172:175], a[252:255], v[204:207]
    ds_read_b128 a[200:203], v247 offset:19456
    ds_read_b128 a[204:207], v248 offset:19456
    v_mfma_f32_16x16x32_bf16 v[216:219], a[176:179], a[224:227], v[252:255]
    s_waitcnt vmcnt(6)
    v_fmac_f32 v240, v24, v212
    v_fmac_f32 v241, v25, v213
    v_mfma_f32_16x16x32_bf16 v[216:219], a[180:183], a[228:231], v[216:219]
    s_waitcnt vmcnt(5) lgkmcnt(6)
    v_cvt_pk_bf16_f32 v140, v240, v241
    v_lshlrev_b32 v242, 16, v141
    v_mfma_f32_16x16x32_bf16 v[216:219], a[184:187], a[232:235], v[216:219]
    s_waitcnt vmcnt(4)
    ds_read_b128 v[232:235], v251 offset:1040
    v_and_b32 v243, s84, v141
    v_mfma_f32_16x16x32_bf16 v[216:219], a[188:191], a[236:239], v[216:219]
    v_fmac_f32 v242, v26, v214
    v_fmac_f32 v243, v27, v215
    v_cvt_pk_bf16_f32 v141, v242, v243
    v_lshlrev_b32 v240, 16, v156
    v_and_b32 v241, s84, v156
    v_lshlrev_b32 v242, 16, v157
    v_mfma_f32_16x16x32_bf16 v[196:199], a[176:179], a[240:243], v[252:255]
    v_fmac_f32 v240, v56, v204
    v_fmac_f32 v241, v57, v205
    v_cvt_pk_bf16_f32 v156, v240, v241
    v_and_b32 v243, s84, v157
    v_fmac_f32 v242, v58, v206
    v_fmac_f32 v243, v59, v207
    v_mfma_f32_16x16x32_bf16 v[196:199], a[180:183], a[244:247], v[196:199]
    ds_read_b128 v[252:255], v251 offset:1152
    v_cvt_pk_bf16_f32 v157, v242, v243
    v_lshlrev_b32 v240, 16, v142
    v_and_b32 v241, s84, v142
    v_lshlrev_b32 v242, 16, v143
    v_and_b32 v243, s84, v143
    v_mfma_f32_16x16x32_bf16 v[196:199], a[184:187], a[248:251], v[196:199]
    v_fmac_f32 v240, v28, v216
    v_fmac_f32 v241, v29, v217
    v_cvt_pk_bf16_f32 v142, v240, v241
    v_fmac_f32 v242, v30, v218
    v_fmac_f32 v243, v31, v219
    v_cvt_pk_bf16_f32 v143, v242, v243
    v_mfma_f32_16x16x32_bf16 v[196:199], a[188:191], a[252:255], v[196:199]
    s_waitcnt lgkmcnt(2)
    ds_write_b128 v244, v[140:143] offset:2304
    v_mfma_f32_16x16x32_bf16 v[220:223], a[64:67], a[192:195], v[236:239]
    v_lshlrev_b32 v240, 16, v158
    v_and_b32 v241, s84, v158
    v_mfma_f32_16x16x32_bf16 v[220:223], a[68:71], a[196:199], v[220:223]
    ds_read_b128 a[16:19], v250 offset:2240
    ds_read_b128 a[20:23], v250 offset:3392
    ds_read_b128 v[236:239], v251 offset:1168
    v_lshlrev_b32 v242, 16, v159
    v_and_b32 v243, s84, v159
    v_mfma_f32_16x16x32_bf16 v[220:223], a[72:75], a[200:203], v[220:223]
    v_fmac_f32 v240, v60, v196
    v_fmac_f32 v241, v61, v197
    v_cvt_pk_bf16_f32 v158, v240, v241
    v_fmac_f32 v242, v62, v198
    v_fmac_f32 v243, v63, v199
    v_cvt_pk_bf16_f32 v159, v242, v243
    v_mfma_f32_16x16x32_bf16 v[220:223], a[76:79], a[204:207], v[220:223]
    s_waitcnt lgkmcnt(5)
    ds_write_b128 v244, v[156:159] offset:6784
    v_mfma_f32_16x16x32_bf16 v[208:211], a[80:83], a[192:195], v[232:235]
    v_lshlrev_b32 v240, 16, v160
    v_and_b32 v241, s84, v160
    v_mfma_f32_16x16x32_bf16 v[208:211], a[84:87], a[196:199], v[208:211]
    s_waitcnt lgkmcnt(3)
    buffer_store_dwordx4 a[16:19], v249, s[56:59], s64 offen offset:128 nt
    v_mfma_f32_16x16x32_bf16 v[208:211], a[88:91], a[200:203], v[208:211]
    ds_read_b128 a[24:27], v250 offset:6720
    ds_read_b128 a[28:31], v250 offset:7872
    v_lshlrev_b32 v242, 16, v161
    v_fmac_f32 v240, v64, v220
    v_fmac_f32 v241, v65, v221
    v_cvt_pk_bf16_f32 v160, v240, v241
    v_mfma_f32_16x16x32_bf16 v[208:211], a[92:95], a[204:207], v[208:211]
    s_waitcnt lgkmcnt(4)
    buffer_store_dwordx4 a[20:23], v249, s[56:59], s66 offen offset:128 nt
    v_mfma_f32_16x16x32_bf16 v[228:231], a[96:99], a[192:195], v[252:255]
    ds_read_b128 v[232:235], v251 offset:1280
    v_and_b32 v243, s84, v161
    v_fmac_f32 v242, v66, v222
    v_fmac_f32 v243, v67, v223
    v_cvt_pk_bf16_f32 v161, v242, v243
    v_lshlrev_b32 v240, 16, v162
    v_mfma_f32_16x16x32_bf16 v[228:231], a[100:103], a[196:199], v[228:231]
    v_and_b32 v241, s84, v162
    v_lshlrev_b32 v242, 16, v163
    v_and_b32 v243, s84, v163
    v_mfma_f32_16x16x32_bf16 v[228:231], a[104:107], a[200:203], v[228:231]
    s_waitcnt lgkmcnt(2)
    buffer_store_dwordx4 a[24:27], v249, s[56:59], s68 offen offset:128 nt
    v_mfma_f32_16x16x32_bf16 v[228:231], a[108:111], a[204:207], v[228:231]
    s_waitcnt lgkmcnt(1)
    buffer_store_dwordx4 a[28:31], v249, s[56:59], s70 offen offset:128 nt
    v_mfma_f32_16x16x32_bf16 v[224:227], a[112:115], a[192:195], v[236:239]
    v_fmac_f32 v240, v68, v208
    v_fmac_f32 v241, v69, v209
    v_cvt_pk_bf16_f32 v162, v240, v241
    v_fmac_f32 v242, v70, v210
    v_fmac_f32 v243, v71, v211
    v_cvt_pk_bf16_f32 v163, v242, v243
    v_mfma_f32_16x16x32_bf16 v[224:227], a[116:119], a[196:199], v[224:227]
    ds_write_b128 v244, v[160:163] offset:0
    v_mfma_f32_16x16x32_bf16 v[224:227], a[120:123], a[200:203], v[224:227]
    v_lshlrev_b32 v240, 16, v164
    v_and_b32 v241, s84, v164
    v_mfma_f32_16x16x32_bf16 v[224:227], a[124:127], a[204:207], v[224:227]
    s_waitcnt lgkmcnt(1)
    ds_read_b128 v[252:255], v251 offset:1296
    ds_read_b128 a[208:211], v245 offset:20480
    v_lshlrev_b32 v242, 16, v165
    v_mfma_f32_16x16x32_bf16 v[192:195], a[128:131], a[192:195], v[232:235]
    ds_read_b128 v[236:239], v251 offset:1408
    v_fmac_f32 v240, v72, v228
    v_fmac_f32 v241, v73, v229
    v_cvt_pk_bf16_f32 v164, v240, v241
    v_and_b32 v243, s84, v165
    v_fmac_f32 v242, v74, v230
    v_mfma_f32_16x16x32_bf16 v[192:195], a[132:135], a[196:199], v[192:195]
    v_fmac_f32 v243, v75, v231
    v_cvt_pk_bf16_f32 v165, v242, v243
    v_lshlrev_b32 v240, 16, v166
    v_and_b32 v241, s84, v166
    v_lshlrev_b32 v242, 16, v167
    v_and_b32 v243, s84, v167
    v_mfma_f32_16x16x32_bf16 v[192:195], a[136:139], a[200:203], v[192:195]
    v_fmac_f32 v240, v76, v224
    v_fmac_f32 v241, v77, v225
    v_cvt_pk_bf16_f32 v166, v240, v241
    v_fmac_f32 v242, v78, v226
    v_fmac_f32 v243, v79, v227
    v_cvt_pk_bf16_f32 v167, v242, v243
    v_mfma_f32_16x16x32_bf16 v[192:195], a[140:143], a[204:207], v[192:195]
    s_waitcnt lgkmcnt(2)
    ds_write_b128 v244, v[164:167] offset:64
    v_mfma_f32_16x16x32_bf16 v[200:203], a[144:147], a[192:195], v[252:255]
    v_add_u32 v249, 0x8000, v249
    v_lshlrev_b32 v240, 16, v168
    v_mfma_f32_16x16x32_bf16 v[200:203], a[148:151], a[196:199], v[200:203]
    ds_read_b128 a[32:35], v250 offset:0
    ds_read_b128 a[36:39], v250 offset:1152
    ds_read_b128 a[212:215], v246 offset:20480
    ds_read_b128 v[232:235], v251 offset:1424
    v_mfma_f32_16x16x32_bf16 v[200:203], a[152:155], a[200:203], v[200:203]
    ds_read_b128 a[216:219], v247 offset:20480
    ds_read_b128 a[220:223], v248 offset:20480
    v_mfma_f32_16x16x32_bf16 v[200:203], a[156:159], a[204:207], v[200:203]
    s_waitcnt lgkmcnt(7)
    v_and_b32 v241, s84, v168
    v_lshlrev_b32 v242, 16, v169
    v_mfma_f32_16x16x32_bf16 v[212:215], a[160:163], a[192:195], v[236:239]
    ds_read_b128 v[252:255], v251 offset:1024
    v_fmac_f32 v240, v80, v192
    v_mfma_f32_16x16x32_bf16 v[212:215], a[164:167], a[196:199], v[212:215]
    s_waitcnt lgkmcnt(6)
    buffer_store_dwordx4 a[32:35], v249, s[56:59], s64 offen offset:0 nt
    v_mfma_f32_16x16x32_bf16 v[212:215], a[168:171], a[200:203], v[212:215]
    s_waitcnt lgkmcnt(5)
    buffer_store_dwordx4 a[36:39], v249, s[56:59], s66 offen offset:0 nt
    v_mfma_f32_16x16x32_bf16 v[212:215], a[172:175], a[204:207], v[212:215]
    s_waitcnt lgkmcnt(3)
    v_fmac_f32 v241, v81, v193
    v_cvt_pk_bf16_f32 v168, v240, v241
    v_and_b32 v243, s84, v169
    v_fmac_f32 v242, v82, v194
    v_fmac_f32 v243, v83, v195
    v_cvt_pk_bf16_f32 v169, v242, v243
    v_mfma_f32_16x16x32_bf16 v[204:207], a[176:179], a[192:195], v[232:235]
    ds_read_b128 v[236:239], v251 offset:1040
    v_lshlrev_b32 v240, 16, v170
    v_and_b32 v241, s84, v170
    v_lshlrev_b32 v242, 16, v171
    v_and_b32 v243, s84, v171
    v_fmac_f32 v240, v84, v200
    v_mfma_f32_16x16x32_bf16 v[204:207], a[180:183], a[196:199], v[204:207]
    v_fmac_f32 v241, v85, v201
    v_cvt_pk_bf16_f32 v170, v240, v241
    v_fmac_f32 v242, v86, v202
    v_fmac_f32 v243, v87, v203
    v_cvt_pk_bf16_f32 v171, v242, v243
    v_mfma_f32_16x16x32_bf16 v[204:207], a[184:187], a[200:203], v[204:207]
    ds_write_b128 v244, v[168:171] offset:2240
    v_mfma_f32_16x16x32_bf16 v[204:207], a[188:191], a[204:207], v[204:207]
    s_waitcnt lgkmcnt(2)
    v_lshlrev_b32 v240, 16, v172
    v_and_b32 v241, s84, v172
    v_lshlrev_b32 v242, 16, v173
    v_mfma_f32_16x16x32_bf16 v[216:219], a[64:67], a[208:211], v[252:255]
    ds_read_b128 v[232:235], v251 offset:1152
    v_fmac_f32 v240, v88, v212
    v_fmac_f32 v241, v89, v213
    v_cvt_pk_bf16_f32 v172, v240, v241
    v_and_b32 v243, s84, v173
    v_fmac_f32 v242, v90, v214
    v_mfma_f32_16x16x32_bf16 v[216:219], a[68:71], a[212:215], v[216:219]
    v_fmac_f32 v243, v91, v215
    v_cvt_pk_bf16_f32 v173, v242, v243
    v_lshlrev_b32 v240, 16, v174
    v_and_b32 v241, s84, v174
    v_lshlrev_b32 v242, 16, v175
    v_and_b32 v243, s84, v175
    v_mfma_f32_16x16x32_bf16 v[216:219], a[72:75], a[216:219], v[216:219]
    v_fmac_f32 v240, v92, v204
    v_fmac_f32 v241, v93, v205
    v_cvt_pk_bf16_f32 v174, v240, v241
    v_fmac_f32 v242, v94, v206
    v_fmac_f32 v243, v95, v207
    v_cvt_pk_bf16_f32 v175, v242, v243
    v_mfma_f32_16x16x32_bf16 v[216:219], a[76:79], a[220:223], v[216:219]
    s_waitcnt lgkmcnt(2)
    ds_write_b128 v244, v[172:175] offset:2304
    v_mfma_f32_16x16x32_bf16 v[196:199], a[80:83], a[208:211], v[236:239]
    v_lshlrev_b32 v240, 16, v176
    v_and_b32 v241, s84, v176
    v_mfma_f32_16x16x32_bf16 v[196:199], a[84:87], a[212:215], v[196:199]
    ds_read_b128 a[40:43], v250 offset:2240
    ds_read_b128 a[44:47], v250 offset:3392
    ds_read_b128 v[252:255], v251 offset:1168
    v_mfma_f32_16x16x32_bf16 v[196:199], a[88:91], a[216:219], v[196:199]
    ds_read_b128 v[236:239], v251 offset:1280
    v_lshlrev_b32 v242, 16, v177
    v_mfma_f32_16x16x32_bf16 v[196:199], a[92:95], a[220:223], v[196:199]
    s_waitcnt lgkmcnt(5)
    v_fmac_f32 v240, v96, v216
    v_fmac_f32 v241, v97, v217
    v_mfma_f32_16x16x32_bf16 v[220:223], a[96:99], a[208:211], v[232:235]
    v_cvt_pk_bf16_f32 v176, v240, v241
    v_and_b32 v243, s84, v177
    v_mfma_f32_16x16x32_bf16 v[220:223], a[100:103], a[212:215], v[220:223]
    s_waitcnt lgkmcnt(3)
    buffer_store_dwordx4 a[40:43], v249, s[56:59], s64 offen offset:128 nt
    v_mfma_f32_16x16x32_bf16 v[220:223], a[104:107], a[216:219], v[220:223]
    s_waitcnt lgkmcnt(2)
    buffer_store_dwordx4 a[44:47], v249, s[56:59], s66 offen offset:128 nt
    v_mfma_f32_16x16x32_bf16 v[220:223], a[108:111], a[220:223], v[220:223]
    s_waitcnt lgkmcnt(1)
    v_fmac_f32 v242, v98, v218
    v_fmac_f32 v243, v99, v219
    v_cvt_pk_bf16_f32 v177, v242, v243
    v_lshlrev_b32 v240, 16, v178
    v_and_b32 v241, s84, v178
    v_lshlrev_b32 v242, 16, v179
    v_mfma_f32_16x16x32_bf16 v[208:211], a[112:115], a[208:211], v[252:255]
    ds_read_b128 v[232:235], v251 offset:1296
    v_and_b32 v243, s84, v179
    v_fmac_f32 v240, v100, v196
    v_fmac_f32 v241, v101, v197
    v_cvt_pk_bf16_f32 v178, v240, v241
    v_fmac_f32 v242, v102, v198
    v_mfma_f32_16x16x32_bf16 v[208:211], a[116:119], a[212:215], v[208:211]
    v_fmac_f32 v243, v103, v199
    v_cvt_pk_bf16_f32 v179, v242, v243
    v_mfma_f32_16x16x32_bf16 v[208:211], a[120:123], a[216:219], v[208:211]
    ds_write_b128 v244, v[176:179] offset:4480
    v_mfma_f32_16x16x32_bf16 v[208:211], a[124:127], a[220:223], v[208:211]
    s_waitcnt lgkmcnt(2)
    v_lshlrev_b32 v240, 16, v180
    v_and_b32 v241, s84, v180
    v_lshlrev_b32 v242, 16, v181
    v_mfma_f32_16x16x32_bf16 v[228:231], a[128:131], a[208:211], v[236:239]
    ds_read_b128 v[252:255], v251 offset:1408
    v_fmac_f32 v240, v104, v220
    v_fmac_f32 v241, v105, v221
    v_cvt_pk_bf16_f32 v180, v240, v241
    v_and_b32 v243, s84, v181
    v_fmac_f32 v242, v106, v222
    v_mfma_f32_16x16x32_bf16 v[228:231], a[132:135], a[212:215], v[228:231]
    v_fmac_f32 v243, v107, v223
    v_cvt_pk_bf16_f32 v181, v242, v243
    v_lshlrev_b32 v240, 16, v182
    v_and_b32 v241, s84, v182
    v_lshlrev_b32 v242, 16, v183
    v_and_b32 v243, s84, v183
    v_mfma_f32_16x16x32_bf16 v[228:231], a[136:139], a[216:219], v[228:231]
    v_fmac_f32 v240, v108, v208
    v_fmac_f32 v241, v109, v209
    v_cvt_pk_bf16_f32 v182, v240, v241
    v_fmac_f32 v242, v110, v210
    v_fmac_f32 v243, v111, v211
    v_cvt_pk_bf16_f32 v183, v242, v243
    v_mfma_f32_16x16x32_bf16 v[228:231], a[140:143], a[220:223], v[228:231]
    s_waitcnt lgkmcnt(2)
    ds_write_b128 v244, v[180:183] offset:4544
    v_mfma_f32_16x16x32_bf16 v[224:227], a[144:147], a[208:211], v[232:235]
    v_lshlrev_b32 v240, 16, v184
    v_and_b32 v241, s84, v184
    v_mfma_f32_16x16x32_bf16 v[224:227], a[148:151], a[212:215], v[224:227]
    ds_read_b128 a[48:51], v250 offset:4480
    ds_read_b128 a[52:55], v250 offset:5632
    ds_read_b128 v[236:239], v251 offset:1424
    v_mfma_f32_16x16x32_bf16 v[224:227], a[152:155], a[216:219], v[224:227]
    v_fmac_f32 v240, v112, v228
    v_fmac_f32 v241, v113, v229
    v_mfma_f32_16x16x32_bf16 v[224:227], a[156:159], a[220:223], v[224:227]
    s_waitcnt lgkmcnt(4)
    v_cvt_pk_bf16_f32 v184, v240, v241
    v_lshlrev_b32 v242, 16, v185
    v_mfma_f32_16x16x32_bf16 v[192:195], a[160:163], a[208:211], v[252:255]
    v_and_b32 v243, s84, v185
    v_fmac_f32 v242, v114, v230
    v_mfma_f32_16x16x32_bf16 v[192:195], a[164:167], a[212:215], v[192:195]
    s_waitcnt lgkmcnt(2)
    buffer_store_dwordx4 a[48:51], v249, s[56:59], s68 offen offset:0 nt
    v_mfma_f32_16x16x32_bf16 v[192:195], a[168:171], a[216:219], v[192:195]
    s_waitcnt lgkmcnt(1)
    buffer_store_dwordx4 a[52:55], v249, s[56:59], s70 offen offset:0
    v_mfma_f32_16x16x32_bf16 v[192:195], a[172:175], a[220:223], v[192:195]
    s_waitcnt lgkmcnt(0)
    v_fmac_f32 v243, v115, v231
    v_cvt_pk_bf16_f32 v185, v242, v243
    v_lshlrev_b32 v240, 16, v186
    v_and_b32 v241, s84, v186
    v_lshlrev_b32 v242, 16, v187
    v_and_b32 v243, s84, v187
    v_mfma_f32_16x16x32_bf16 v[200:203], a[176:179], a[208:211], v[236:239]
    v_fmac_f32 v240, v116, v224
    v_fmac_f32 v241, v117, v225
    v_cvt_pk_bf16_f32 v186, v240, v241
    v_fmac_f32 v242, v118, v226
    v_fmac_f32 v243, v119, v227
    v_cvt_pk_bf16_f32 v187, v242, v243
    v_mfma_f32_16x16x32_bf16 v[200:203], a[180:183], a[212:215], v[200:203]
    ds_write_b128 v244, v[184:187] offset:6720
    v_mfma_f32_16x16x32_bf16 v[200:203], a[184:187], a[216:219], v[200:203]
    v_lshlrev_b32 v240, 16, v188
    v_and_b32 v241, s84, v188
    v_fmac_f32 v240, v120, v192
    v_fmac_f32 v241, v121, v193
    v_lshlrev_b32 v242, 16, v189
    v_and_b32 v243, s84, v189
    v_mfma_f32_16x16x32_bf16 v[200:203], a[188:191], a[220:223], v[200:203]
    v_cvt_pk_bf16_f32 v188, v240, v241
    v_fmac_f32 v242, v122, v194
    v_fmac_f32 v243, v123, v195
    v_cvt_pk_bf16_f32 v189, v242, v243
    v_lshlrev_b32 v240, 16, v190
    v_and_b32 v241, s84, v190
    v_lshlrev_b32 v242, 16, v191
    v_and_b32 v243, s84, v191
    v_fmac_f32 v240, v124, v200
    v_fmac_f32 v241, v125, v201
    v_cvt_pk_bf16_f32 v190, v240, v241
    v_fmac_f32 v242, v126, v202
    v_fmac_f32 v243, v127, v203
    v_cvt_pk_bf16_f32 v191, v242, v243
    ds_write_b128 v244, v[188:191] offset:6784
    ds_read_b128 a[56:59], v250 offset:6720
    ds_read_b128 a[60:63], v250 offset:7872
    s_waitcnt lgkmcnt(0)
    buffer_store_dwordx4 a[56:59], v249, s[56:59], s68 offen offset:128
    buffer_store_dwordx4 a[60:63], v249, s[56:59], s70 offen offset:128
L_done:
    s_endpgm
L_spin:
    s_mov_b32 s3, 400
L_spin1:
    s_cmp_eq_u32 s3, 0
    s_cbranch_scc1 L_fb
    buffer_load_dword v126, v127, s[56:59], 0 offen sc1
    s_sub_u32 s3, s3, 1
    s_waitcnt vmcnt(0)
    v_cmp_eq_u32 vcc, 0, v126
    s_cbranch_vccnz L_spin1
    s_branch L_back
L_fb:
    v_bfe_u32 v120, v96, 6, 2
    v_bfe_u32 v121, v96, 4, 2
    v_lshl_add_u32 v120, v120, 3, v121
    v_lshrrev_b32 v121, 8, v96
    v_lshlrev_b32 v121, 4, v121
    s_mov_b32 s1, 0
    s_mov_b32 s58, 0x60000
    s_mov_b32 s59, 0x20000
L_fb1:
    s_lshr_b32 s3, s1, 3
    s_add_u32 s3, s3, 1
    s_lshr_b32 s14, s3, 1
    s_lshl_b32 s82, s14, 17
    s_lshl_b32 s14, s85, 15
    s_add_u32 s82, s82, s14
    s_bfe_u32 s14, s1, 0x20001
    s_add_u32 s15, s14, s85
    s_and_b32 s15, s15, 3
    s_lshl_b32 s15, s15, 8
    s_lshl_b32 s14, s14, 13
    s_bitcmp1_b32 s3, 0
    s_cselect_b32 s14, s14, s15
    s_cselect_b32 s56, s6, s8
    s_cselect_b32 s57, s7, s9
    s_cselect_b32 s15, 8, 10
    s_cselect_b32 s3, s85, 0
    s_add_u32 s82, s82, s14
    v_lshlrev_b32 v122, s15, v120
    s_and_b32 s14, s1, 1
    s_add_u32 s15, s15, 2
    s_lshl_b32 s14, s14, s15
    s_add_u32 s82, s82, s14
    v_add_u32 v122, v122, v121
    s_lshr_b32 s14, s1, 3
    s_lshl_b32 s14, s14, 17
    s_and_b32 s15, s1, 7
    s_lshl_b32 s15, s15, 12
    s_add_u32 s14, s14, s15
    s_lshl_b32 s15, s85, 15
    s_add_u32 s14, s14, s15
    s_sub_u32 s15, 0, s3
    s_and_b32 s15, s15, 3
    s_lshl_b32 s15, s15, 7
    s_add_u32 s76, s14, s15
    s_sub_u32 s15, 1, s3
    s_and_b32 s15, s15, 3
    s_lshl_b32 s15, s15, 7
    s_add_u32 s77, s14, s15
    s_sub_u32 s15, 2, s3
    s_and_b32 s15, s15, 3
    s_lshl_b32 s15, s15, 7
    s_add_u32 s78, s14, s15
    s_sub_u32 s15, 3, s3
    s_and_b32 s15, s15, 3
    s_lshl_b32 s15, s15, 7
    s_add_u32 s79, s14, s15
    buffer_load_dwordx4 v[112:115], v122, s[56:59], s82 offen offset:0
    buffer_load_dwordx4 v[116:119], v122, s[56:59], s82 offen offset:64
    s_waitcnt vmcnt(0)
    buffer_store_dwordx4 v[112:115], v125, s[16:19], s76 offen sc1
    buffer_store_dwordx4 v[116:119], v125, s[16:19], s77 offen sc1
    s_waitcnt vmcnt(0)
    buffer_load_dwordx4 v[112:115], v122, s[56:59], s82 offen offset:128
    buffer_load_dwordx4 v[116:119], v122, s[56:59], s82 offen offset:192
    s_waitcnt vmcnt(0)
    buffer_store_dwordx4 v[112:115], v125, s[16:19], s78 offen sc1
    buffer_store_dwordx4 v[116:119], v125, s[16:19], s79 offen sc1
    s_waitcnt vmcnt(0)
    s_add_u32 s1, s1, 1
    s_cmp_lt_u32 s1, 40
    s_cbranch_scc1 L_fb1
    s_branch L_back
L_end:
.section .rodata,"a"
.p2align 6
.amdhsa_kernel standalone__cross_network_dcn_v2__recsys_kernel
  .amdhsa_next_free_vgpr 512
  .amdhsa_next_free_sgpr 102
  .amdhsa_accum_offset 256
  .amdhsa_group_segment_fixed_size 0
  .amdhsa_kernarg_size 56
  .amdhsa_user_sgpr_count 2
  .amdhsa_user_sgpr_kernarg_segment_ptr 1
  .amdhsa_system_sgpr_workgroup_id_x 1
.end_amdhsa_kernel
```
